```python
import torch

def _softmax(x, axis=-1):
    return torch.softmax(x, dim=axis)
def _gelu(x):
    return torch.nn.functional.gelu(x, approximate="tanh")
def _silu(x):
    return torch.nn.functional.silu(x)
def _sigmoid(x):
    return torch.sigmoid(x)
def _layernorm(x, axis=-1, eps=1e-5):
    m = x.mean(dim=axis, keepdim=True)
    v = x.var(dim=axis, keepdim=True, unbiased=False)
    return (x - m) / torch.sqrt(v + eps)
def _scatter_add(tgt, idx, src, axis=0):
    return tgt.clone().index_add_(axis, idx, src)
def _segment_sum(src, seg, n):
    out = torch.zeros((n,) + src.shape[1:], dtype=src.dtype)
    return out.index_add_(0, seg, src)
def _pad(x, pw):
    flat = tuple(v for pair in reversed(pw) for v in pair)
    return torch.nn.functional.pad(x, flat)

kernel_name = 'recurrent_scan__spectral_gfnet__mixer_channel_mlp__prompt'

def setup_inputs():

    _w = (lambda a: (lambda t: t.to(torch.bfloat16) if t.is_floating_point() else t)(torch.as_tensor(a)))
    def _A_setup():
        B, S, D = 1, 2048, 640
        Df = D // 2 + 1
        return {
            "x": _w((lambda *s: torch.randn(*s, dtype=torch.bfloat16) * 0.05)(B, S, D)),
            "w_r": _w((lambda *s: torch.randn(*s, dtype=torch.bfloat16) * 0.8)(S, Df) * 0.02),
            "w_i": _w((lambda *s: torch.randn(*s, dtype=torch.bfloat16) * 0.8)(S, Df) * 0.02),
        }
    _A_in = _A_setup()

    def _B_setup():
        B, S, D, F = 1, 2048, 640, 1536
        return {
            "x": _w((lambda *s: torch.randn(*s, dtype=torch.bfloat16) * 0.05)(B, S, D)),
            "w1": _w((lambda *s: torch.randn(*s, dtype=torch.bfloat16) * 3.2)(D, F) * (D ** -0.5)),
            "b1": _w((lambda *s: torch.randn(*s, dtype=torch.bfloat16) * 1.6)(F)),
            "w2": _w((lambda *s: torch.randn(*s, dtype=torch.bfloat16) * 0.2)(F, D) * (F ** -0.5)),
            "b2": _w((lambda *s: torch.randn(*s, dtype=torch.bfloat16) * 0.2)(D)),
        }
    _B_in = _B_setup()

    return {
        "A_x": _A_in["x"],
        "A_w_r": _A_in["w_r"],
        "A_w_i": _A_in["w_i"],
        "B_x": _B_in["x"],
        "B_w1": _B_in["w1"],
        "B_b1": _B_in["b1"],
        "B_w2": _B_in["w2"],
        "B_b2": _B_in["b2"],
    }

def reference(A_x, A_w_r, A_w_i, B_x, B_w1, B_b1, B_w2, B_b2):
    def _A_ref(x, w_r, w_i):
        B, S, D = x.shape
        X = (lambda x, axes=(-2,-1): torch.fft.rfft2(x.float(), dim=axes))(x, axes=(-2, -1))
        W = w_r + 1j * w_i
        X = X * W
        y = (lambda x, s, axes=(-2,-1): torch.fft.irfft2(x, s=s, dim=axes).to(torch.bfloat16))(X, (S, D), axes=(-2, -1))
        return y

    def _B_ref(x, w1, b1, w2, b2):
        y = _layernorm(x, axis=-1)
        h = _gelu(torch.einsum("bsd,df->bsf", y, w1) + b1)
        return torch.einsum("bsf,fd->bsd", h, w2) + b2

    x = A_x
    xn = _layernorm(x, axis=-1)
    s = _A_ref(xn, A_w_r, A_w_i)
    g = _silu(_B_ref(xn, B_w1, B_b1, B_w2, B_b2))
    return x + s * g
```

```asm
; @launch grid=(256,1,1) block=(512,1,1) lds=163840
.amdgcn_target "amdgcn-amd-amdhsa--gfx950"
.text
.globl recurrent_scan__spectral_gfnet__mixer_channel_mlp__prompt_kernel
.p2align 8
.type recurrent_scan__spectral_gfnet__mixer_channel_mlp__prompt_kernel,@function
recurrent_scan__spectral_gfnet__mixer_channel_mlp__prompt_kernel:
    s_load_dwordx16 s[64:79], s[0:1], 0
    s_load_dwordx4 s[80:83], s[0:1], 64
    s_load_dwordx2 s[84:85], s[0:1], 80
    s_cmp_ge_u32 s2, 256
    s_cbranch_scc1 L_done
    s_getpc_b64 s[20:21]
L_pc:
    s_sub_u32 s20, s20, L_pc-recurrent_scan__spectral_gfnet__mixer_channel_mlp__prompt_kernel
    s_subb_u32 s21, s21, 0
    s_and_b32 s21, s21, 0xffff
    s_mov_b32 s22, kernel_end-recurrent_scan__spectral_gfnet__mixer_channel_mlp__prompt_kernel
    s_mov_b32 s23, 0x00020000
    s_lshr_b32 s5, s2, 3
    s_and_b32 s44, s5, 7
    s_lshl_b32 s44, s44, 13
    v_lshlrev_b32 v1, 4, v0
    buffer_load_dword v167, v1, s[20:23], s44 offen
    v_lshrrev_b32 v1, 6, v0
    s_and_b32 s4, s2, 7
    v_readfirstlane_b32 s3, v1
    v_and_b32 v1, 63, v0
    v_and_b32 v2, 31, v0
    v_bfe_u32 v3, v0, 5, 1
    s_mul_i32 s42, s4, 3
    s_and_b32 s42, s42, 7
    s_lshl_b32 s41, s42, 5
    s_add_u32 s41, s41, s5
    s_lshr_b32 s43, s5, 2
    s_mul_i32 s43, s43, 0
    s_lshr_b32 s43, s43, 5
    s_and_b32 s43, s43, 7
    s_and_b32 s63, s3, 3
    s_cmp_lt_u32 s3, 4
    s_cbranch_scc1 L_lo
    s_lshl_b32 s48, s42, 8
    s_lshl_b32 s49, s5, 1
    s_add_u32 s48, s48, s49
    s_lshl_b32 s49, s63, 6
    s_add_u32 s48, s48, s49
    s_mul_i32 s48, s48, 1280
    s_mul_i32 s50, s63, 2560
    s_add_u32 s50, s50, 131328
    s_mov_b32 m0, s50
    v_lshlrev_b32 v8, 4, v1
    s_setprio 3
    s_waitcnt lgkmcnt(0)
    s_mov_b32 s8, s64
    s_and_b32 s9, s65, 0xffff
    s_mov_b32 s10, 0x280000
    s_mov_b32 s11, 0x00020000
    buffer_load_dwordx4 v8, s[8:11], s48 offen offset:0 lds
    buffer_load_dwordx4 v8, s[8:11], s48 offen offset:1024 lds
    s_mov_b64 exec, 0xffffffff
    buffer_load_dwordx4 v8, s[8:11], s48 offen offset:2048 lds
    s_mov_b64 exec, -1
    s_mov_b32 s28, s82
    s_and_b32 s29, s83, 0xffff
    s_mov_b32 s30, 0x100
    s_mov_b32 s31, 0x00020000
    s_or_b32 s49, s2, s63
    s_cmp_lg_u32 s49, 0
    s_cbranch_scc1 L_1
    s_memrealtime s[56:57]
    s_waitcnt lgkmcnt(0)
    s_or_b32 s56, s56, 1
    v_mov_b32 v14, s56
    v_mov_b32 v15, s57
    s_mov_b64 exec, 1
    buffer_store_dwordx2 v[14:15], off, s[28:31], 0 sc1
    s_mov_b64 exec, -1
L_1:
    v_lshlrev_b32 v8, 2, v1
    v_add_u32 v8, 131072, v8
    v_mov_b32 v9, 0
    ds_write_b32 v8, v9
    s_cmp_lg_u32 s3, 6
    s_cbranch_scc1 L_2
    s_cmp_ge_u32 s5, 24
    s_cbranch_scc1 L_2
    s_mul_i32 s45, s4, 6
    s_lshr_b32 s46, s5, 2
    s_add_u32 s45, s45, s46
    s_and_b32 s44, s45, 15
    s_lshr_b32 s45, s45, 4
    s_and_b32 s46, s5, 3
    s_lshl_b32 s47, s45, 2
    s_add_u32 s47, s47, s46
    s_mov_b32 s16, s72
    s_and_b32 s17, s73, 0xffff
    s_mov_b32 s18, 0x1e0000
    s_mov_b32 s19, 0x00020000
    s_mul_i32 s49, s44, 122880
    s_lshl_b32 s48, s47, 8
    s_add_u32 s49, s49, s48
    v_lshrrev_b32 v8, 4, v1
    v_mul_u32_u24 v8, 3072, v8
    v_and_b32 v9, 15, v1
    v_lshl_add_u32 v8, v9, 4, v8
    buffer_load_dwordx4 v[108:111], v8, s[16:19], s49 offen
    s_add_u32 s49, s49, 12288
    buffer_load_dwordx4 v[112:115], v8, s[16:19], s49 offen
    s_add_u32 s49, s49, 12288
    buffer_load_dwordx4 v[116:119], v8, s[16:19], s49 offen
    s_add_u32 s49, s49, 12288
    buffer_load_dwordx4 v[120:123], v8, s[16:19], s49 offen
    s_add_u32 s49, s49, 12288
    buffer_load_dwordx4 v[124:127], v8, s[16:19], s49 offen
    s_add_u32 s49, s49, 12288
    buffer_load_dwordx4 v[128:131], v8, s[16:19], s49 offen
    s_add_u32 s49, s49, 12288
    buffer_load_dwordx4 v[132:135], v8, s[16:19], s49 offen
    s_add_u32 s49, s49, 12288
    buffer_load_dwordx4 v[136:139], v8, s[16:19], s49 offen
    s_add_u32 s49, s49, 12288
    buffer_load_dwordx4 v[140:143], v8, s[16:19], s49 offen
    s_add_u32 s49, s49, 12288
    buffer_load_dwordx4 v[144:147], v8, s[16:19], s49 offen
    s_add_u32 s49, s49, 12288
L_2:
    s_waitcnt lgkmcnt(0)
    s_barrier
    s_branch L_R2
L_lo:
    s_setprio 3
    s_cmp_lt_u32 s5, 24
    s_cbranch_scc1 L_3
    s_barrier
    s_branch L_Fw
L_3:
    s_mul_i32 s45, s4, 6
    s_lshr_b32 s46, s5, 2
    s_add_u32 s45, s45, s46
    s_and_b32 s44, s45, 15
    s_lshr_b32 s45, s45, 4
    s_and_b32 s46, s5, 3
    s_lshl_b32 s47, s45, 2
    s_add_u32 s47, s47, s46
    s_lshr_b32 s51, s44, 1
    s_lshl_b32 s51, s51, 8
    s_and_b32 s49, s44, 1
    s_lshl_b32 s49, s49, 5
    s_add_u32 s51, s51, s49
    s_lshl_b32 s49, s63, 3
    s_add_u32 s51, s51, s49
    s_mul_i32 s51, s51, 1280
    v_bfe_u32 v8, v1, 3, 1
    v_bfe_u32 v9, v1, 4, 1
    v_lshl_add_u32 v8, v9, 6, v8
    v_lshl_add_u32 v8, v3, 1, v8
    v_mul_u32_u24 v8, 1280, v8
    v_and_b32 v9, 7, v1
    v_lshrrev_b32 v10, 4, v1
    v_xor_b32 v9, v9, v10
    v_lshl_add_u32 v152, v9, 4, v8
    v_xor_b32 v153, 64, v152
    v_add_u32 v153, 163840, v153
    v_add_u32 v154, 5120, v152
    v_add_u32 v155, 5120, v153
    v_bfe_u32 v9, v1, 2, 2
    v_xor_b32 v9, v9, v10
    v_mul_u32_u24 v156, 3072, v10
    v_lshl_add_u32 v156, v9, 6, v156
    v_and_b32 v11, 3, v1
    v_lshl_add_u32 v156, v11, 4, v156
    s_mul_i32 s52, s63, 49152
    s_lshl_b32 s49, s47, 8
    s_add_u32 s52, s52, s49
    s_lshl_b32 s53, s63, 12
    s_lshr_b32 s55, s5, 2
    s_add_u32 s55, s55, s46
    s_and_b32 s55, s55, 3
    s_mov_b32 s54, 0
    s_waitcnt lgkmcnt(0)
    s_mov_b32 s8, s64
    s_and_b32 s9, s65, 0xffff
    s_mov_b32 s10, 0x280000
    s_mov_b32 s11, 0x00020000
    s_mov_b32 s16, s72
    s_and_b32 s17, s73, 0xffff
    s_mov_b32 s18, 0x1e0000
    s_mov_b32 s19, 0x00020000
    s_barrier
L_4:
    s_and_b32 s49, s55, 1
    s_cmp_lt_u32 s54, 8
    s_cselect_b32 s49, s55, s49
    s_xor_b32 s49, s49, s54
    s_mul_i32 s50, s49, 196608
    s_lshl_b32 s49, s49, 7
    s_add_u32 s49, s49, s51
    s_add_u32 s50, s50, s52
    s_sub_u32 s48, 1, s54
    s_and_b32 s48, s48, 3
    s_lshl_b32 s48, s48, 15
    s_add_u32 m0, s48, s53
    s_add_u32 s54, s54, 1
    buffer_load_dwordx4 v152, s[8:11], s49 offen lds
    s_add_u32 m0, m0, 1024
    s_nop 0
    buffer_load_dwordx4 v153, s[8:11], s49 offen lds
    s_add_u32 m0, m0, 1024
    s_nop 0
    buffer_load_dwordx4 v154, s[8:11], s49 offen lds
    s_add_u32 m0, m0, 1024
    s_nop 0
    buffer_load_dwordx4 v155, s[8:11], s49 offen lds
    s_add_u32 m0, m0, 13312
    s_nop 0
    buffer_load_dwordx4 v156, s[16:19], s50 offen lds
    s_add_u32 m0, m0, 1024
    s_add_u32 s50, s50, 12288
    buffer_load_dwordx4 v156, s[16:19], s50 offen lds
    s_add_u32 m0, m0, 1024
    s_add_u32 s50, s50, 12288
    buffer_load_dwordx4 v156, s[16:19], s50 offen lds
    s_add_u32 m0, m0, 1024
    s_add_u32 s50, s50, 12288
    buffer_load_dwordx4 v156, s[16:19], s50 offen lds
    s_cmp_lt_u32 s54, 3
    s_cbranch_scc1 L_4
    s_branch L_Gc
L_R2:
    s_setprio 1
    v_mov_b32 v20, 131072
    v_mov_b32 v54, 0
    v_mov_b32 v55, 0
    s_getpc_b64 s[38:39]
L_rpc:
    s_add_u32 s38, s38, L_rback-L_rpc
    s_addc_u32 s39, s39, 0
L_consts:
    v_cvt_f32_u32 v4, v2
    v_cvt_f32_u32 v5, v3
    v_bfe_u32 v8, v2, 2, 1
    v_mul_u32_u24 v8, 10, v8
    v_lshrrev_b32 v9, 3, v2
    v_lshl_add_u32 v8, v9, 2, v8
    v_and_b32 v9, 3, v2
    v_add_u32 v8, v8, v9
    v_cvt_f32_u32 v6, v8
    v_mul_f32 v8, 0x3d4ccccd, v6
    v_mul_f32 v9, v6, v5
    v_mul_f32 v9, 0.5, v9
    v_fmamk_f32 v180, v8, 0x00000000, v9
    v_fmamk_f32 v181, v8, 0x3f800000, v9
    v_fmamk_f32 v182, v8, 0x40000000, v9
    v_fmamk_f32 v183, v8, 0x40400000, v9
    v_fmamk_f32 v184, v8, 0x40800000, v9
    v_fmamk_f32 v185, v8, 0x40a00000, v9
    v_fmamk_f32 v186, v8, 0x40c00000, v9
    v_fmamk_f32 v187, v8, 0x40e00000, v9
    v_fmamk_f32 v188, v8, 0x41000000, v9
    v_fmamk_f32 v189, v8, 0x41100000, v9
    v_cos_f32 v224, v180
    v_sin_f32 v228, v180
    v_cos_f32 v225, v181
    v_sin_f32 v229, v181
    v_cos_f32 v226, v182
    v_sin_f32 v230, v182
    v_cos_f32 v227, v183
    v_sin_f32 v231, v183
    v_cvt_pk_bf16_f32 v168, v224, v228
    v_cvt_pk_bf16_f32 v180, -v228, v224
    v_cvt_pk_bf16_f32 v169, v225, v229
    v_cvt_pk_bf16_f32 v181, -v229, v225
    v_cvt_pk_bf16_f32 v170, v226, v230
    v_cvt_pk_bf16_f32 v182, -v230, v226
    v_cvt_pk_bf16_f32 v171, v227, v231
    v_cvt_pk_bf16_f32 v183, -v231, v227
    v_cos_f32 v224, v184
    v_sin_f32 v228, v184
    v_cos_f32 v225, v185
    v_sin_f32 v229, v185
    v_cos_f32 v226, v186
    v_sin_f32 v230, v186
    v_cos_f32 v227, v187
    v_sin_f32 v231, v187
    v_cvt_pk_bf16_f32 v172, v224, v228
    v_cvt_pk_bf16_f32 v184, -v228, v224
    v_cvt_pk_bf16_f32 v173, v225, v229
    v_cvt_pk_bf16_f32 v185, -v229, v225
    v_cvt_pk_bf16_f32 v174, v226, v230
    v_cvt_pk_bf16_f32 v186, -v230, v226
    v_cvt_pk_bf16_f32 v175, v227, v231
    v_cvt_pk_bf16_f32 v187, -v231, v227
    v_cos_f32 v224, v188
    v_sin_f32 v228, v188
    v_cos_f32 v225, v189
    v_sin_f32 v229, v189
    v_cvt_pk_bf16_f32 v176, v224, v228
    v_cvt_pk_bf16_f32 v188, -v228, v224
    v_cvt_pk_bf16_f32 v177, v225, v229
    v_cvt_pk_bf16_f32 v189, -v229, v225
    v_mov_b32 v178, 0
    v_mov_b32 v190, 0
    v_mov_b32 v179, 0
    v_mov_b32 v191, 0
    v_mul_f32 v8, 0x3d000000, v4
    v_mul_f32 v9, v8, v5
    v_mul_f32 v9, 4.0, v9
    v_fmamk_f32 v208, v8, 0x00000000, v9
    v_fmamk_f32 v209, v8, 0x3f800000, v9
    v_fmamk_f32 v210, v8, 0x40000000, v9
    v_fmamk_f32 v211, v8, 0x40400000, v9
    v_fmamk_f32 v212, v8, 0x41000000, v9
    v_fmamk_f32 v213, v8, 0x41100000, v9
    v_fmamk_f32 v214, v8, 0x41200000, v9
    v_fmamk_f32 v215, v8, 0x41300000, v9
    v_fmamk_f32 v216, v8, 0x41800000, v9
    v_fmamk_f32 v217, v8, 0x41880000, v9
    v_fmamk_f32 v218, v8, 0x41900000, v9
    v_fmamk_f32 v219, v8, 0x41980000, v9
    v_fmamk_f32 v220, v8, 0x41c00000, v9
    v_fmamk_f32 v221, v8, 0x41c80000, v9
    v_fmamk_f32 v222, v8, 0x41d00000, v9
    v_fmamk_f32 v223, v8, 0x41d80000, v9
    v_cos_f32 v224, v208
    v_sin_f32 v228, v208
    v_cos_f32 v225, v209
    v_sin_f32 v229, v209
    v_cos_f32 v226, v210
    v_sin_f32 v230, v210
    v_cos_f32 v227, v211
    v_sin_f32 v231, v211
    v_cvt_pk_bf16_f32 v192, v224, v228
    v_cvt_pk_bf16_f32 v208, -v228, v224
    v_cvt_pk_bf16_f32 v193, v225, v229
    v_cvt_pk_bf16_f32 v209, -v229, v225
    v_cvt_pk_bf16_f32 v194, v226, v230
    v_cvt_pk_bf16_f32 v210, -v230, v226
    v_cvt_pk_bf16_f32 v195, v227, v231
    v_cvt_pk_bf16_f32 v211, -v231, v227
    v_cos_f32 v224, v212
    v_sin_f32 v228, v212
    v_cos_f32 v225, v213
    v_sin_f32 v229, v213
    v_cos_f32 v226, v214
    v_sin_f32 v230, v214
    v_cos_f32 v227, v215
    v_sin_f32 v231, v215
    v_cvt_pk_bf16_f32 v196, v224, v228
    v_cvt_pk_bf16_f32 v212, -v228, v224
    v_cvt_pk_bf16_f32 v197, v225, v229
    v_cvt_pk_bf16_f32 v213, -v229, v225
    v_cvt_pk_bf16_f32 v198, v226, v230
    v_cvt_pk_bf16_f32 v214, -v230, v226
    v_cvt_pk_bf16_f32 v199, v227, v231
    v_cvt_pk_bf16_f32 v215, -v231, v227
    v_cos_f32 v224, v216
    v_sin_f32 v228, v216
    v_cos_f32 v225, v217
    v_sin_f32 v229, v217
    v_cos_f32 v226, v218
    v_sin_f32 v230, v218
    v_cos_f32 v227, v219
    v_sin_f32 v231, v219
    v_cvt_pk_bf16_f32 v200, v224, v228
    v_cvt_pk_bf16_f32 v216, -v228, v224
    v_cvt_pk_bf16_f32 v201, v225, v229
    v_cvt_pk_bf16_f32 v217, -v229, v225
    v_cvt_pk_bf16_f32 v202, v226, v230
    v_cvt_pk_bf16_f32 v218, -v230, v226
    v_cvt_pk_bf16_f32 v203, v227, v231
    v_cvt_pk_bf16_f32 v219, -v231, v227
    v_cos_f32 v224, v220
    v_sin_f32 v228, v220
    v_cos_f32 v225, v221
    v_sin_f32 v229, v221
    v_cos_f32 v226, v222
    v_sin_f32 v230, v222
    v_cos_f32 v227, v223
    v_sin_f32 v231, v223
    v_cvt_pk_bf16_f32 v204, v224, v228
    v_cvt_pk_bf16_f32 v220, -v228, v224
    v_cvt_pk_bf16_f32 v205, v225, v229
    v_cvt_pk_bf16_f32 v221, -v229, v225
    v_cvt_pk_bf16_f32 v206, v226, v230
    v_cvt_pk_bf16_f32 v222, -v230, v226
    v_cvt_pk_bf16_f32 v207, v227, v231
    v_cvt_pk_bf16_f32 v223, -v231, v227
    v_mul_f32 v8, 0x3acccccd, v6
    v_mul_f32 v9, v8, v5
    v_mul_f32 v9, 4.0, v9
    v_fmamk_f32 v240, v8, 0x00000000, v9
    v_fmamk_f32 v241, v8, 0x3f800000, v9
    v_fmamk_f32 v242, v8, 0x40000000, v9
    v_fmamk_f32 v243, v8, 0x40400000, v9
    v_fmamk_f32 v244, v8, 0x41000000, v9
    v_fmamk_f32 v245, v8, 0x41100000, v9
    v_fmamk_f32 v246, v8, 0x41200000, v9
    v_fmamk_f32 v247, v8, 0x41300000, v9
    v_fmamk_f32 v248, v8, 0x41800000, v9
    v_fmamk_f32 v249, v8, 0x41880000, v9
    v_fmamk_f32 v250, v8, 0x41900000, v9
    v_fmamk_f32 v251, v8, 0x41980000, v9
    v_fmamk_f32 v252, v8, 0x41c00000, v9
    v_fmamk_f32 v253, v8, 0x41c80000, v9
    v_fmamk_f32 v254, v8, 0x41d00000, v9
    v_fmamk_f32 v255, v8, 0x41d80000, v9
    v_cos_f32 v224, v240
    v_sin_f32 v240, v240
    v_cos_f32 v225, v241
    v_sin_f32 v241, v241
    v_cos_f32 v226, v242
    v_sin_f32 v242, v242
    v_cos_f32 v227, v243
    v_sin_f32 v243, v243
    v_cos_f32 v228, v244
    v_sin_f32 v244, v244
    v_cos_f32 v229, v245
    v_sin_f32 v245, v245
    v_cos_f32 v230, v246
    v_sin_f32 v246, v246
    v_cos_f32 v231, v247
    v_sin_f32 v247, v247
    v_cos_f32 v232, v248
    v_sin_f32 v248, v248
    v_cos_f32 v233, v249
    v_sin_f32 v249, v249
    v_cos_f32 v234, v250
    v_sin_f32 v250, v250
    v_cos_f32 v235, v251
    v_sin_f32 v251, v251
    v_cos_f32 v236, v252
    v_sin_f32 v252, v252
    v_cos_f32 v237, v253
    v_sin_f32 v253, v253
    v_cos_f32 v238, v254
    v_sin_f32 v254, v254
    v_cos_f32 v239, v255
    v_sin_f32 v255, v255
    s_nop 0
    s_setpc_b64 s[38:39]
L_rback:
    v_mul_u32_u24 v18, 640, v3
    v_lshl_add_u32 v18, v2, 1, v18
    v_add_u32 v18, s50, v18
    v_and_b32 v8, 1, v1
    v_cmp_eq_u32 s[56:57], 1, v8
    s_mov_b32 s12, s84
    s_and_b32 s13, s85, 0xffff
    s_mov_b32 s14, 0x1848000
    s_mov_b32 s15, 0x00020000
    s_mov_b32 s16, s72
    s_and_b32 s17, s73, 0xffff
    s_mov_b32 s18, 0x1e0000
    s_mov_b32 s19, 0x00020000
    s_lshl_b32 s49, s63, 2
    s_add_u32 s49, s49, 142080
    v_mul_u32_u24 v19, 336, v2
    v_mul_u32_u24 v8, 160, v3
    v_add3_u32 v19, v19, v8, s49
    s_cmp_eq_u32 s3, 7
    s_cbranch_scc1 L_5
    s_mul_i32 s45, s4, 6
    s_lshr_b32 s46, s5, 2
    s_add_u32 s45, s45, s46
    s_and_b32 s44, s45, 15
    s_lshr_b32 s45, s45, 4
    s_and_b32 s46, s5, 3
    s_lshl_b32 s47, s45, 2
    s_add_u32 s47, s47, s46
    s_lshr_b32 s51, s44, 1
    s_lshl_b32 s51, s51, 8
    s_and_b32 s49, s44, 1
    s_lshl_b32 s49, s49, 5
    s_add_u32 s51, s51, s49
    s_lshl_b32 s49, s63, 4
    s_add_u32 s51, s51, s49
    s_mul_i32 s51, s51, 1280
    v_bfe_u32 v8, v1, 3, 1
    v_bfe_u32 v9, v1, 4, 1
    v_lshl_add_u32 v8, v9, 6, v8
    v_lshl_add_u32 v8, v3, 1, v8
    v_mul_u32_u24 v8, 1280, v8
    v_and_b32 v9, 7, v1
    v_lshrrev_b32 v10, 4, v1
    v_xor_b32 v9, v9, v10
    v_lshl_add_u32 v152, v9, 4, v8
    v_xor_b32 v153, 64, v152
    v_add_u32 v153, 163840, v153
    v_add_u32 v154, 5120, v152
    v_add_u32 v155, 5120, v153
    v_bfe_u32 v9, v1, 2, 2
    v_xor_b32 v9, v9, v10
    v_mul_u32_u24 v156, 3072, v10
    v_lshl_add_u32 v156, v9, 6, v156
    v_and_b32 v11, 3, v1
    v_lshl_add_u32 v156, v11, 4, v156
    s_mul_i32 s52, s63, 98304
    s_lshl_b32 s49, s47, 8
    s_add_u32 s52, s52, s49
    s_lshl_b32 s53, s63, 13
    s_lshr_b32 s55, s5, 2
    s_add_u32 s55, s55, s46
    s_and_b32 s55, s55, 3
    s_mov_b32 s54, 3
    s_branch L_6
L_5:
    v_mov_b32 v13, 142080
    v_mov_b32 v8, 1344
    v_mov_b32 v159, -1344
    v_cndmask_b32 v159, v8, v159, s[56:57]
    v_add_u32 v9, 0, v1
    v_mul_u32_u24 v10, 5462, v9
    v_lshrrev_b32 v10, 16, v10
    v_mul_u32_u24 v12, 49344, v10
    v_lshl_add_u32 v152, v9, 4, v12
    v_lshrrev_b32 v11, 1, v9
    v_sub_u32 v11, v11, v10
    v_sub_u32 v12, 640, v11
    v_cndmask_b32 v11, v11, v12, s[56:57]
    v_mul_u32_u24 v12, 3277, v11
    v_lshrrev_b32 v12, 16, v12
    v_add_u32 v12, v12, v11
    v_lshl_add_u32 v155, v12, 4, v13
    v_add_u32 v9, 64, v1
    v_mul_u32_u24 v10, 5462, v9
    v_lshrrev_b32 v10, 16, v10
    v_mul_u32_u24 v12, 49344, v10
    v_lshl_add_u32 v153, v9, 4, v12
    v_lshrrev_b32 v11, 1, v9
    v_sub_u32 v11, v11, v10
    v_sub_u32 v12, 640, v11
    v_cndmask_b32 v11, v11, v12, s[56:57]
    v_mul_u32_u24 v12, 3277, v11
    v_lshrrev_b32 v12, 16, v12
    v_add_u32 v12, v12, v11
    v_lshl_add_u32 v156, v12, 4, v13
    v_add_u32 v9, 128, v1
    v_mul_u32_u24 v10, 5462, v9
    v_lshrrev_b32 v10, 16, v10
    v_mul_u32_u24 v12, 49344, v10
    v_lshl_add_u32 v154, v9, 4, v12
    v_lshrrev_b32 v11, 1, v9
    v_sub_u32 v11, v11, v10
    v_sub_u32 v12, 640, v11
    v_cndmask_b32 v11, v11, v12, s[56:57]
    v_mul_u32_u24 v12, 3277, v11
    v_lshrrev_b32 v12, 16, v12
    v_add_u32 v12, v12, v11
    v_lshl_add_u32 v157, v12, 4, v13
    v_mov_b32 v158, v155
    s_movk_i32 s49, 336
    s_lshl_b32 s49, s49, 4
    s_add_u32 s49, s49, 142080
    v_writelane_b32 v158, s49, 1
L_6:
    s_waitcnt vmcnt(10)
    s_cmp_lg_u32 s3, 6
    s_cbranch_scc1 L_8
    s_cmp_lt_u32 s5, 24
    s_cbranch_scc1 L_7
L_8:
    s_waitcnt vmcnt(0)
L_7:
    ds_read_u16_d16_hi v24, v18 offset:0
    ds_read_u16_d16_hi v25, v18 offset:64
    ds_read_u16_d16_hi v26, v18 offset:128
    ds_read_u16_d16_hi v27, v18 offset:192
    ds_read_u16_d16_hi v28, v18 offset:256
    ds_read_u16_d16_hi v29, v18 offset:320
    ds_read_u16_d16_hi v30, v18 offset:384
    ds_read_u16_d16_hi v31, v18 offset:448
    ds_read_u16_d16_hi v32, v18 offset:512
    ds_read_u16_d16_hi v33, v18 offset:576
    ds_read_u16_d16_hi v34, v18 offset:1280
    ds_read_u16_d16_hi v35, v18 offset:1344
    ds_read_u16_d16_hi v36, v18 offset:1408
    ds_read_u16_d16_hi v37, v18 offset:1472
    ds_read_u16_d16_hi v38, v18 offset:1536
    s_waitcnt lgkmcnt(14)
    ds_read_u16_d16_hi v39, v18 offset:1600
    s_waitcnt lgkmcnt(14)
    ds_read_u16_d16_hi v40, v18 offset:1664
    s_waitcnt lgkmcnt(14)
    ds_read_u16_d16_hi v41, v18 offset:1728
    s_waitcnt lgkmcnt(14)
    ds_read_u16_d16_hi v42, v18 offset:1792
    s_waitcnt lgkmcnt(14)
    ds_read_u16_d16_hi v43, v18 offset:1856
    s_waitcnt lgkmcnt(10)
    v_pk_add_f32 v[96:97], v[24:25], v[26:27]
    v_pk_mul_f32 v[98:99], v[24:25], v[24:25]
    v_pk_fma_f32 v[98:99], v[26:27], v[26:27], v[98:99]
    v_pk_fma_f32 v[98:99], v[28:29], v[28:29], v[98:99]
    v_pk_add_f32 v[96:97], v[96:97], v[28:29]
    v_pk_fma_f32 v[98:99], v[30:31], v[30:31], v[98:99]
    v_pk_add_f32 v[96:97], v[96:97], v[30:31]
    v_pk_fma_f32 v[98:99], v[32:33], v[32:33], v[98:99]
    v_pk_add_f32 v[96:97], v[96:97], v[32:33]
    v_add_f32 v92, v96, v97
    v_add_f32 v94, v98, v99
    s_waitcnt lgkmcnt(0)
    v_pk_add_f32 v[96:97], v[34:35], v[36:37]
    v_pk_mul_f32 v[98:99], v[34:35], v[34:35]
    v_pk_fma_f32 v[98:99], v[36:37], v[36:37], v[98:99]
    v_pk_fma_f32 v[98:99], v[38:39], v[38:39], v[98:99]
    v_pk_add_f32 v[96:97], v[96:97], v[38:39]
    v_pk_fma_f32 v[98:99], v[40:41], v[40:41], v[98:99]
    v_pk_add_f32 v[96:97], v[96:97], v[40:41]
    v_pk_fma_f32 v[98:99], v[42:43], v[42:43], v[98:99]
    v_pk_add_f32 v[96:97], v[96:97], v[42:43]
    v_add_f32 v93, v96, v97
    v_add_f32 v95, v98, v99
    v_cndmask_b32 v96, v93, v92, s[56:57]
    v_cndmask_b32 v92, v92, v93, s[56:57]
    v_cndmask_b32 v97, v95, v94, s[56:57]
    v_cndmask_b32 v94, v94, v95, s[56:57]
    v_add_f32_dpp v92, v96, v92 quad_perm:[1,0,3,2] row_mask:0xf bank_mask:0xf
    s_nop 0
    v_add_f32_dpp v94, v97, v94 quad_perm:[1,0,3,2] row_mask:0xf bank_mask:0xf
    v_add_f32_dpp v92, v92, v92 quad_perm:[2,3,0,1] row_mask:0xf bank_mask:0xf
    s_nop 0
    v_add_f32_dpp v94, v94, v94 quad_perm:[2,3,0,1] row_mask:0xf bank_mask:0xf
    v_add_f32_dpp v92, v92, v92 row_ror:4 row_mask:0xf bank_mask:0xf
    s_nop 0
    v_add_f32_dpp v94, v94, v94 row_ror:4 row_mask:0xf bank_mask:0xf
    v_add_f32_dpp v92, v92, v92 row_ror:8 row_mask:0xf bank_mask:0xf
    s_nop 0
    v_add_f32_dpp v94, v94, v94 row_ror:8 row_mask:0xf bank_mask:0xf
    v_mov_b32 v96, v92
    v_mov_b32 v97, v94
    s_nop 0
    v_permlane16_swap_b32 v92, v96
    v_permlane16_swap_b32 v94, v97
    v_add_f32 v92, v92, v96
    v_add_f32 v94, v94, v97
    v_mov_b32 v96, v92
    v_mov_b32 v97, v94
    s_nop 0
    v_permlane32_swap_b32 v92, v96
    v_permlane32_swap_b32 v94, v97
    v_add_f32 v92, v92, v96
    v_add_f32 v94, v94, v97
    v_mul_f32 v92, 0x3acccccd, v92
    v_mul_f32 v94, 0x3acccccd, v94
    v_fma_f32 v94, -v92, v92, v94
    v_max_f32 v94, 0, v94
    v_cvt_pk_bf16_f32 v99, v92, v94
    v_and_b32 v95, 0xffff0000, v99
    v_lshlrev_b32 v93, 16, v99
    v_add_f32 v95, 0x3727c5ac, v95
    v_cvt_pk_bf16_f32 v95, v95, v95
    v_lshlrev_b32 v95, 16, v95
    v_sqrt_f32 v95, v95
    s_nop 0
    v_cvt_pk_bf16_f32 v95, v95, v95
    v_lshlrev_b32 v95, 16, v95
    v_rcp_f32 v96, v95
    s_nop 0
    v_mul_f32_e64 v100, -v93, v96
    v_mov_b32_dpp v60, v96 quad_perm:[0,0,0,0] row_mask:0xf bank_mask:0xf
    v_mov_b32_dpp v61, v96 quad_perm:[0,0,0,0] row_mask:0xf bank_mask:0xf
    v_mov_b32_dpp v62, v96 quad_perm:[1,1,1,1] row_mask:0xf bank_mask:0xf
    v_mov_b32_dpp v63, v96 quad_perm:[1,1,1,1] row_mask:0xf bank_mask:0xf
    v_mov_b32_dpp v64, v100 quad_perm:[0,0,0,0] row_mask:0xf bank_mask:0xf
    v_mov_b32_dpp v65, v100 quad_perm:[0,0,0,0] row_mask:0xf bank_mask:0xf
    v_mov_b32_dpp v66, v100 quad_perm:[1,1,1,1] row_mask:0xf bank_mask:0xf
    v_mov_b32_dpp v67, v100 quad_perm:[1,1,1,1] row_mask:0xf bank_mask:0xf
    v_pk_fma_f32 v[24:25], v[24:25], v[60:61], v[64:65]
    v_pk_fma_f32 v[26:27], v[26:27], v[60:61], v[64:65]
    v_pk_fma_f32 v[28:29], v[28:29], v[60:61], v[64:65]
    v_pk_fma_f32 v[30:31], v[30:31], v[60:61], v[64:65]
    v_pk_fma_f32 v[32:33], v[32:33], v[60:61], v[64:65]
    v_pk_fma_f32 v[34:35], v[34:35], v[62:63], v[66:67]
    v_pk_fma_f32 v[36:37], v[36:37], v[62:63], v[66:67]
    v_pk_fma_f32 v[38:39], v[38:39], v[62:63], v[66:67]
    v_pk_fma_f32 v[40:41], v[40:41], v[62:63], v[66:67]
    v_pk_fma_f32 v[42:43], v[42:43], v[62:63], v[66:67]
    v_cvt_pk_bf16_f32 v44, v24, v34
    v_cvt_pk_bf16_f32 v45, v25, v35
    v_cvt_pk_bf16_f32 v46, v26, v36
    v_cvt_pk_bf16_f32 v47, v27, v37
    v_cvt_pk_bf16_f32 v48, v28, v38
    v_cvt_pk_bf16_f32 v49, v29, v39
    v_cvt_pk_bf16_f32 v50, v30, v40
    v_cvt_pk_bf16_f32 v51, v31, v41
    v_cvt_pk_bf16_f32 v52, v32, v42
    v_cvt_pk_bf16_f32 v53, v33, v43
    v_mfma_f32_32x32x16_bf16 v[60:75], v[44:47], v[168:171], 0
    v_sub_f32 v97, v92, v93
    v_mul_f32 v98, v94, v96
    v_mul_f32 v97, v97, v96
    v_mfma_f32_32x32x16_bf16 v[76:91], v[44:47], v[180:183], 0
    v_mul_f32 v98, v98, v96
    v_cvt_pk_bf16_f32 v99, v97, v98
    v_and_b32 v98, 0xffff0000, v99
    v_mfma_f32_32x32x16_bf16 v[60:75], v[48:51], v[172:175], v[60:75]
    v_lshlrev_b32 v97, 16, v99
    v_add_f32 v98, 0x3727c5ac, v98
    v_cvt_pk_bf16_f32 v98, v98, v98
    v_lshlrev_b32 v98, 16, v98
    v_mfma_f32_32x32x16_bf16 v[76:91], v[48:51], v[184:187], v[76:91]
    v_sqrt_f32 v98, v98
    v_fma_f32 v56, v97, v95, v93
    v_cvt_pk_bf16_f32 v98, v98, v98
    v_mfma_f32_32x32x16_bf16 v[60:75], v[52:55], v[176:179], v[60:75]
    v_lshlrev_b32 v98, 16, v98
    v_mul_f32 v57, v95, v98
    s_lshl_b32 s49, s63, 4
    v_mfma_f32_32x32x16_bf16 v[76:91], v[52:55], v[188:191], v[76:91]
    v_and_b32 v8, 1, v1
    v_lshl_add_u32 v8, v8, 3, v20
    v_add_u32 v8, s49, v8
    ds_write_b64 v8, v[56:57] offset:192
    s_nop 3
    v_pk_mul_f32 v[24:25], v[60:61], v[224:225]
    s_nop 2
    v_pk_mul_f32 v[26:27], v[76:77], v[224:225]
    v_pk_mul_f32 v[28:29], v[62:63], v[226:227]
    v_pk_mul_f32 v[30:31], v[78:79], v[226:227]
    v_pk_fma_f32 v[24:25], v[76:77], v[240:241], v[24:25]
    v_pk_fma_f32 v[26:27], v[60:61], v[240:241], v[26:27] neg_lo:[1,0,0] neg_hi:[1,0,0]
    v_pk_fma_f32 v[28:29], v[78:79], v[242:243], v[28:29]
    v_pk_fma_f32 v[30:31], v[62:63], v[242:243], v[30:31] neg_lo:[1,0,0] neg_hi:[1,0,0]
    v_cvt_pk_bf16_f32 v92, v24, v26
    v_cvt_pk_bf16_f32 v93, v25, v27
    v_cvt_pk_bf16_f32 v94, v28, v30
    v_cvt_pk_bf16_f32 v95, v29, v31
    v_pk_mul_f32 v[24:25], v[64:65], v[228:229]
    v_pk_mul_f32 v[26:27], v[80:81], v[228:229]
    v_pk_mul_f32 v[28:29], v[66:67], v[230:231]
    v_pk_mul_f32 v[30:31], v[82:83], v[230:231]
    v_pk_fma_f32 v[24:25], v[80:81], v[244:245], v[24:25]
    v_pk_fma_f32 v[26:27], v[64:65], v[244:245], v[26:27] neg_lo:[1,0,0] neg_hi:[1,0,0]
    v_pk_fma_f32 v[28:29], v[82:83], v[246:247], v[28:29]
    v_pk_fma_f32 v[30:31], v[66:67], v[246:247], v[30:31] neg_lo:[1,0,0] neg_hi:[1,0,0]
    v_cvt_pk_bf16_f32 v96, v24, v26
    v_cvt_pk_bf16_f32 v97, v25, v27
    v_cvt_pk_bf16_f32 v98, v28, v30
    v_cvt_pk_bf16_f32 v99, v29, v31
    v_pk_mul_f32 v[24:25], v[68:69], v[232:233]
    v_pk_mul_f32 v[26:27], v[84:85], v[232:233]
    v_pk_mul_f32 v[28:29], v[70:71], v[234:235]
    v_pk_mul_f32 v[30:31], v[86:87], v[234:235]
    v_pk_fma_f32 v[24:25], v[84:85], v[248:249], v[24:25]
    v_pk_fma_f32 v[26:27], v[68:69], v[248:249], v[26:27] neg_lo:[1,0,0] neg_hi:[1,0,0]
    v_pk_fma_f32 v[28:29], v[86:87], v[250:251], v[28:29]
    v_pk_fma_f32 v[30:31], v[70:71], v[250:251], v[30:31] neg_lo:[1,0,0] neg_hi:[1,0,0]
    v_cvt_pk_bf16_f32 v100, v24, v26
    v_cvt_pk_bf16_f32 v101, v25, v27
    v_cvt_pk_bf16_f32 v102, v28, v30
    v_cvt_pk_bf16_f32 v103, v29, v31
    v_pk_mul_f32 v[24:25], v[72:73], v[236:237]
    v_pk_mul_f32 v[26:27], v[88:89], v[236:237]
    v_pk_mul_f32 v[28:29], v[74:75], v[238:239]
    v_pk_mul_f32 v[30:31], v[90:91], v[238:239]
    v_pk_fma_f32 v[24:25], v[88:89], v[252:253], v[24:25]
    v_pk_fma_f32 v[26:27], v[72:73], v[252:253], v[26:27] neg_lo:[1,0,0] neg_hi:[1,0,0]
    v_pk_fma_f32 v[28:29], v[90:91], v[254:255], v[28:29]
    v_pk_fma_f32 v[30:31], v[74:75], v[254:255], v[30:31] neg_lo:[1,0,0] neg_hi:[1,0,0]
    v_cvt_pk_bf16_f32 v104, v24, v26
    v_cvt_pk_bf16_f32 v105, v25, v27
    v_cvt_pk_bf16_f32 v106, v28, v30
    v_cvt_pk_bf16_f32 v107, v29, v31
    v_mfma_f32_32x32x16_bf16 v[60:75], v[92:95], v[192:195], 0
    v_mfma_f32_32x32x16_bf16 v[76:91], v[92:95], v[208:211], 0
    v_mfma_f32_32x32x16_bf16 v[60:75], v[96:99], v[196:199], v[60:75]
    v_mfma_f32_32x32x16_bf16 v[76:91], v[96:99], v[212:215], v[76:91]
    v_mfma_f32_32x32x16_bf16 v[60:75], v[100:103], v[200:203], v[60:75]
    v_mfma_f32_32x32x16_bf16 v[76:91], v[100:103], v[216:219], v[76:91]
    v_mfma_f32_32x32x16_bf16 v[60:75], v[104:107], v[204:207], v[60:75]
    v_mfma_f32_32x32x16_bf16 v[76:91], v[104:107], v[220:223], v[76:91]
    s_nop 11
    v_cvt_pk_bf16_f32 v44, v60, v76
    ds_write_b32 v19, v44 offset:0
    v_cvt_pk_bf16_f32 v45, v61, v77
    ds_write_b32 v19, v45 offset:16
    v_cvt_pk_bf16_f32 v46, v62, v78
    ds_write_b32 v19, v46 offset:32
    v_cvt_pk_bf16_f32 v47, v63, v79
    ds_write_b32 v19, v47 offset:48
    v_cvt_pk_bf16_f32 v48, v64, v80
    ds_write_b32 v19, v48 offset:64
    v_cvt_pk_bf16_f32 v49, v65, v81
    ds_write_b32 v19, v49 offset:80
    v_cvt_pk_bf16_f32 v50, v66, v82
    ds_write_b32 v19, v50 offset:96
    v_cvt_pk_bf16_f32 v51, v67, v83
    ds_write_b32 v19, v51 offset:112
    v_cvt_pk_bf16_f32 v52, v68, v84
    ds_write_b32 v19, v52 offset:128
    v_cvt_pk_bf16_f32 v53, v69, v85
    ds_write_b32 v19, v53 offset:144
    s_cmp_ge_u32 s5, 24
    s_cbranch_scc1 L_9
    s_waitcnt lgkmcnt(0)
    s_cmp_lg_u32 s3, 7
    s_cbranch_scc1 L_n7
    s_barrier
    s_branch L_10
L_9:
    s_lshl_b32 s49, s63, 2
    v_add_u32 v8, s49, v20
    v_mov_b32 v9, 1
    ds_write_b32 v8, v9 offset:16
    s_cmp_lg_u32 s3, 7
    s_cbranch_scc1 L_n7
    s_mov_b32 s40, 0
lw_11:
    ds_read_b128 v[24:27], v20 offset:16
    s_add_u32 s40, s40, 1
    s_waitcnt lgkmcnt(0)
    v_min3_u32 v24, v24, v25, v26
    v_min_u32 v24, v24, v27
    v_cmp_gt_u32 vcc, 1, v24
    s_cbranch_vccz lwx_12
    s_cmp_lt_u32 s40, 3200000
    s_cbranch_scc1 lw_11
lwx_12:
L_10:
    s_setprio 3
    ds_read_b128 v[104:107], v158
    v_add_u32 v155, v155, v159
    ds_read_b128 v[108:111], v156
    v_add_u32 v156, v156, v159
    ds_read_b128 v[112:115], v157
    v_add_u32 v157, v157, v159
    ds_read_b128 v[116:119], v155
    v_add_u32 v155, v155, v159
    ds_read_b128 v[120:123], v156
    v_add_u32 v156, v156, v159
    ds_read_b128 v[124:127], v157
    v_add_u32 v157, v157, v159
    ds_read_b128 v[128:131], v155
    v_add_u32 v155, v155, v159
    ds_read_b128 v[132:135], v156
    v_add_u32 v156, v156, v159
    ds_read_b128 v[136:139], v157
    v_add_u32 v157, v157, v159
    ds_read_b128 v[140:143], v155
    ds_read_b128 v[144:147], v156
    ds_read_b128 v[148:151], v157
    v_lshlrev_b32 v8, 3, v1
    v_add_u32 v8, 131264, v8
    ds_read_b64 v[10:11], v8
    s_mul_i32 s48, s41, 192
    s_waitcnt lgkmcnt(12)
    buffer_store_dwordx4 v[104:107], v152, s[12:15], s48 offen sc1
    s_waitcnt lgkmcnt(11)
    buffer_store_dwordx4 v[108:111], v153, s[12:15], s48 offen sc1
    s_waitcnt lgkmcnt(10)
    buffer_store_dwordx4 v[112:115], v154, s[12:15], s48 offen sc1
    s_add_u32 s48, s48, 792576
    s_waitcnt lgkmcnt(9)
    buffer_store_dwordx4 v[116:119], v152, s[12:15], s48 offen sc1
    s_waitcnt lgkmcnt(8)
    buffer_store_dwordx4 v[120:123], v153, s[12:15], s48 offen sc1
    s_waitcnt lgkmcnt(7)
    buffer_store_dwordx4 v[124:127], v154, s[12:15], s48 offen sc1
    s_add_u32 s48, s48, 792576
    s_waitcnt lgkmcnt(6)
    buffer_store_dwordx4 v[128:131], v152, s[12:15], s48 offen sc1
    s_waitcnt lgkmcnt(5)
    buffer_store_dwordx4 v[132:135], v153, s[12:15], s48 offen sc1
    s_waitcnt lgkmcnt(4)
    buffer_store_dwordx4 v[136:139], v154, s[12:15], s48 offen sc1
    s_add_u32 s48, s48, 792576
    s_waitcnt lgkmcnt(3)
    buffer_store_dwordx4 v[140:143], v152, s[12:15], s48 offen sc1
    s_waitcnt lgkmcnt(2)
    buffer_store_dwordx4 v[144:147], v153, s[12:15], s48 offen sc1
    s_waitcnt lgkmcnt(1)
    buffer_store_dwordx4 v[148:151], v154, s[12:15], s48 offen sc1
    s_add_u32 s48, s48, 792576
    buffer_load_dwordx2 v[14:15], off, s[28:31], 0 sc1
    s_waitcnt lgkmcnt(0)
    v_mov_b32 v56, v10
    v_mov_b32 v58, v11
L_n7:
    s_cmp_ge_u32 s5, 24
    s_cbranch_scc1 L_Fhi
    s_mov_b32 s20, s76
    s_and_b32 s21, s77, 0xffff
    s_mov_b32 s22, 0x1e0000
    s_mov_b32 s23, 0x00020000
    s_cmp_ge_u32 s3, 6
    s_cbranch_scc1 L_aux
    v_mov_b32 v24, 0
    v_mov_b32 v25, 0
    v_mov_b32 v26, 0
    v_mov_b32 v27, 0
    v_mov_b32 v28, 0
L_13:
    s_waitcnt vmcnt(16)
    s_barrier
L_14:
    s_and_b32 s49, s55, 1
    s_cmp_lt_u32 s54, 8
    s_cselect_b32 s49, s55, s49
    s_xor_b32 s49, s49, s54
    s_mul_i32 s50, s49, 196608
    s_lshl_b32 s49, s49, 7
    s_add_u32 s49, s49, s51
    s_add_u32 s50, s50, s52
    s_sub_u32 s48, 1, s54
    s_and_b32 s48, s48, 3
    s_lshl_b32 s48, s48, 15
    s_add_u32 m0, s48, s53
    s_add_u32 s54, s54, 1
    buffer_load_dwordx4 v152, s[8:11], s49 offen lds
    s_add_u32 m0, m0, 1024
    s_nop 0
    buffer_load_dwordx4 v153, s[8:11], s49 offen lds
    s_add_u32 m0, m0, 1024
    s_nop 0
    buffer_load_dwordx4 v154, s[8:11], s49 offen lds
    s_add_u32 m0, m0, 1024
    s_nop 0
    buffer_load_dwordx4 v155, s[8:11], s49 offen lds
    s_add_u32 m0, m0, 1024
    s_add_u32 s49, s49, 10240
    buffer_load_dwordx4 v152, s[8:11], s49 offen lds
    s_add_u32 m0, m0, 1024
    s_nop 0
    buffer_load_dwordx4 v153, s[8:11], s49 offen lds
    s_add_u32 m0, m0, 1024
    s_nop 0
    buffer_load_dwordx4 v154, s[8:11], s49 offen lds
    s_add_u32 m0, m0, 1024
    s_nop 0
    buffer_load_dwordx4 v155, s[8:11], s49 offen lds
    s_add_u32 m0, m0, 9216
    s_nop 0
    buffer_load_dwordx4 v156, s[16:19], s50 offen lds
    s_add_u32 m0, m0, 1024
    s_add_u32 s50, s50, 12288
    buffer_load_dwordx4 v156, s[16:19], s50 offen lds
    s_add_u32 m0, m0, 1024
    s_add_u32 s50, s50, 12288
    buffer_load_dwordx4 v156, s[16:19], s50 offen lds
    s_add_u32 m0, m0, 1024
    s_add_u32 s50, s50, 12288
    buffer_load_dwordx4 v156, s[16:19], s50 offen lds
    s_add_u32 m0, m0, 1024
    s_add_u32 s50, s50, 12288
    buffer_load_dwordx4 v156, s[16:19], s50 offen lds
    s_add_u32 m0, m0, 1024
    s_add_u32 s50, s50, 12288
    buffer_load_dwordx4 v156, s[16:19], s50 offen lds
    s_add_u32 m0, m0, 1024
    s_add_u32 s50, s50, 12288
    buffer_load_dwordx4 v156, s[16:19], s50 offen lds
    s_add_u32 m0, m0, 1024
    s_add_u32 s50, s50, 12288
    buffer_load_dwordx4 v156, s[16:19], s50 offen lds
    s_cmp_lg_u32 s54, 6
    s_cbranch_scc1 L_15
    v_add_u32 v9, 0, v1
    v_mul_u32_u24 v10, 3277, v9
    v_lshrrev_b32 v10, 16, v10
    v_mul_u32_u24 v10, 960, v10
    v_lshl_add_u32 v24, v9, 4, v10
    v_add_u32 v9, 64, v1
    v_mul_u32_u24 v10, 3277, v9
    v_lshrrev_b32 v10, 16, v10
    v_mul_u32_u24 v10, 960, v10
    v_lshl_add_u32 v25, v9, 4, v10
    v_add_u32 v9, 128, v1
    v_mul_u32_u24 v10, 3277, v9
    v_lshrrev_b32 v10, 16, v10
    v_mul_u32_u24 v10, 960, v10
    v_lshl_add_u32 v26, v9, 4, v10
    v_add_u32 v9, 192, v1
    v_mul_u32_u24 v10, 3277, v9
    v_lshrrev_b32 v10, 16, v10
    v_mul_u32_u24 v10, 960, v10
    v_lshl_add_u32 v27, v9, 4, v10
    v_add_u32 v9, 256, v1
    v_mul_u32_u24 v10, 3277, v9
    v_lshrrev_b32 v10, 16, v10
    v_mul_u32_u24 v10, 960, v10
    v_lshl_add_u32 v28, v9, 4, v10
    s_lshl_b32 s58, s45, 9
    s_lshl_b32 s49, s63, 4
    s_add_u32 s58, s58, s49
    s_mul_i32 s58, s58, 1280
    s_mul_i32 s49, s46, 320
    s_add_u32 s58, s58, s49
    s_mul_i32 s61, s63, 5120
L_15:
    s_cmp_lt_u32 s54, 10
    s_cbranch_scc1 L_13
    s_mul_i32 s60, s45, 655360
    s_lshl_b32 s49, s5, 1
    s_add_u32 s49, s49, s63
    s_mul_i32 s49, s49, 13696
    s_add_u32 s60, s60, s49
    v_lshlrev_b32 v8, 4, v1
    s_waitcnt vmcnt(16)
    s_barrier
    buffer_load_dwordx4 v[32:35], v8, s[20:23], s60 offen
    s_add_u32 s60, s60, 1024
    buffer_load_dwordx4 v[36:39], v8, s[20:23], s60 offen
    s_add_u32 s60, s60, 1024
    buffer_load_dwordx4 v[40:43], v8, s[20:23], s60 offen
    s_add_u32 s60, s60, 1024
    buffer_load_dwordx4 v[44:47], v8, s[20:23], s60 offen
    s_add_u32 s60, s60, 1024
    buffer_load_dwordx4 v[48:51], v8, s[20:23], s60 offen
    s_add_u32 s60, s60, 1024
    buffer_load_dwordx4 v[52:55], v8, s[20:23], s60 offen
    s_add_u32 s60, s60, 1024
    s_waitcnt vmcnt(6)
    s_barrier
    s_setprio 0
    buffer_load_dwordx4 v[56:59], v8, s[20:23], s60 offen
    s_add_u32 s60, s60, 1024
    buffer_load_dwordx4 v[60:63], v8, s[20:23], s60 offen
    s_add_u32 s60, s60, 1024
    buffer_load_dwordx4 v[64:67], v8, s[20:23], s60 offen
    s_add_u32 s60, s60, 1024
    buffer_load_dwordx4 v[68:71], v8, s[20:23], s60 offen
    s_add_u32 s60, s60, 1024
    buffer_load_dwordx4 v[72:75], v8, s[20:23], s60 offen
    s_add_u32 s60, s60, 1024
    buffer_load_dwordx4 v[76:79], v8, s[20:23], s60 offen
    s_add_u32 s60, s60, 1024
    buffer_load_dwordx4 v[80:83], v8, s[20:23], s60 offen
    s_add_u32 s60, s60, 1024
    buffer_load_dwordx4 v[84:87], v8, s[20:23], s60 offen
    s_add_u32 s60, s60, 1024
    s_barrier
    s_sub_u32 s59, 0, s43
    s_and_b32 s59, s59, 7
    s_lshl_b32 s59, s59, 2
    s_lshr_b32 s59, 0x75364210, s59
    s_lshl_b32 s49, s46, 1
    s_add_u32 s59, s59, s49
    s_and_b32 s59, s59, 7
    s_mul_i32 s59, s59, 81920
    s_add_u32 s59, s59, s58
    s_add_u32 m0, s61, 143360
    s_add_u32 s49, s59, 0
    buffer_load_dwordx4 v24, s[20:23], s49 offen lds
    s_add_u32 m0, m0, 1024
    s_nop 0
    buffer_load_dwordx4 v25, s[20:23], s49 offen lds
    s_add_u32 m0, m0, 1024
    s_nop 0
    buffer_load_dwordx4 v26, s[20:23], s49 offen lds
    s_add_u32 m0, m0, 1024
    s_nop 0
    buffer_load_dwordx4 v27, s[20:23], s49 offen lds
    s_add_u32 m0, m0, 1024
    s_nop 0
    buffer_load_dwordx4 v28, s[20:23], s49 offen lds
    s_add_u32 m0, s61, 153600
    s_add_u32 s49, s59, 40960
    buffer_load_dwordx4 v24, s[20:23], s49 offen lds
    s_add_u32 m0, m0, 1024
    s_nop 0
    buffer_load_dwordx4 v25, s[20:23], s49 offen lds
    s_add_u32 m0, m0, 1024
    s_nop 0
    buffer_load_dwordx4 v26, s[20:23], s49 offen lds
    s_add_u32 m0, m0, 1024
    s_nop 0
    buffer_load_dwordx4 v27, s[20:23], s49 offen lds
    s_add_u32 m0, m0, 1024
    s_nop 0
    buffer_load_dwordx4 v28, s[20:23], s49 offen lds
    s_sub_u32 s59, 1, s43
    s_and_b32 s59, s59, 7
    s_lshl_b32 s59, s59, 2
    s_lshr_b32 s59, 0x75364210, s59
    s_lshl_b32 s49, s46, 1
    s_add_u32 s59, s59, s49
    s_and_b32 s59, s59, 7
    s_mul_i32 s59, s59, 81920
    s_add_u32 s59, s59, s58
    s_add_u32 m0, s61, 122880
    s_add_u32 s49, s59, 0
    buffer_load_dwordx4 v24, s[20:23], s49 offen lds
    s_add_u32 m0, m0, 1024
    s_nop 0
    buffer_load_dwordx4 v25, s[20:23], s49 offen lds
    s_add_u32 m0, m0, 1024
    s_nop 0
    buffer_load_dwordx4 v26, s[20:23], s49 offen lds
    s_add_u32 m0, m0, 1024
    s_nop 0
    buffer_load_dwordx4 v27, s[20:23], s49 offen lds
    s_add_u32 m0, m0, 1024
    s_nop 0
    buffer_load_dwordx4 v28, s[20:23], s49 offen lds
    s_barrier
    s_add_u32 m0, s61, 133120
    s_add_u32 s49, s59, 40960
    buffer_load_dwordx4 v24, s[20:23], s49 offen lds
    s_add_u32 m0, m0, 1024
    s_nop 0
    buffer_load_dwordx4 v25, s[20:23], s49 offen lds
    s_add_u32 m0, m0, 1024
    s_nop 0
    buffer_load_dwordx4 v26, s[20:23], s49 offen lds
    s_add_u32 m0, m0, 1024
    s_nop 0
    buffer_load_dwordx4 v27, s[20:23], s49 offen lds
    s_add_u32 m0, m0, 1024
    s_nop 0
    buffer_load_dwordx4 v28, s[20:23], s49 offen lds
    s_sub_u32 s59, 2, s43
    s_and_b32 s59, s59, 7
    s_lshl_b32 s59, s59, 2
    s_lshr_b32 s59, 0x75364210, s59
    s_lshl_b32 s49, s46, 1
    s_add_u32 s59, s59, s49
    s_and_b32 s59, s59, 7
    s_mul_i32 s59, s59, 81920
    s_add_u32 s59, s59, s58
    s_add_u32 m0, s61, 102400
    s_add_u32 s49, s59, 0
    buffer_load_dwordx4 v24, s[20:23], s49 offen lds
    s_add_u32 m0, m0, 1024
    s_nop 0
    buffer_load_dwordx4 v25, s[20:23], s49 offen lds
    s_add_u32 m0, m0, 1024
    s_nop 0
    buffer_load_dwordx4 v26, s[20:23], s49 offen lds
    s_add_u32 m0, m0, 1024
    s_nop 0
    buffer_load_dwordx4 v27, s[20:23], s49 offen lds
    s_add_u32 m0, m0, 1024
    s_nop 0
    buffer_load_dwordx4 v28, s[20:23], s49 offen lds
    s_add_u32 m0, s61, 112640
    s_add_u32 s49, s59, 40960
    buffer_load_dwordx4 v24, s[20:23], s49 offen lds
    s_add_u32 m0, m0, 1024
    s_nop 0
    buffer_load_dwordx4 v25, s[20:23], s49 offen lds
    s_add_u32 m0, m0, 1024
    s_nop 0
    buffer_load_dwordx4 v26, s[20:23], s49 offen lds
    s_add_u32 m0, m0, 1024
    s_nop 0
    buffer_load_dwordx4 v27, s[20:23], s49 offen lds
    s_add_u32 m0, m0, 1024
    s_nop 0
    buffer_load_dwordx4 v28, s[20:23], s49 offen lds
    s_sub_u32 s59, 3, s43
    s_and_b32 s59, s59, 7
    s_lshl_b32 s59, s59, 2
    s_lshr_b32 s59, 0x75364210, s59
    s_lshl_b32 s49, s46, 1
    s_add_u32 s59, s59, s49
    s_and_b32 s59, s59, 7
    s_mul_i32 s59, s59, 81920
    s_add_u32 s59, s59, s58
    s_add_u32 m0, s61, 81920
    s_add_u32 s49, s59, 0
    buffer_load_dwordx4 v24, s[20:23], s49 offen lds
    s_add_u32 m0, m0, 1024
    s_nop 0
    buffer_load_dwordx4 v25, s[20:23], s49 offen lds
    s_add_u32 m0, m0, 1024
    s_nop 0
    buffer_load_dwordx4 v26, s[20:23], s49 offen lds
    s_add_u32 m0, m0, 1024
    s_nop 0
    buffer_load_dwordx4 v27, s[20:23], s49 offen lds
    s_add_u32 m0, m0, 1024
    s_nop 0
    buffer_load_dwordx4 v28, s[20:23], s49 offen lds
    s_add_u32 m0, s61, 92160
    s_add_u32 s49, s59, 40960
    buffer_load_dwordx4 v24, s[20:23], s49 offen lds
    s_add_u32 m0, m0, 1024
    s_nop 0
    buffer_load_dwordx4 v25, s[20:23], s49 offen lds
    s_add_u32 m0, m0, 1024
    s_nop 0
    buffer_load_dwordx4 v26, s[20:23], s49 offen lds
    s_add_u32 m0, m0, 1024
    s_nop 0
    buffer_load_dwordx4 v27, s[20:23], s49 offen lds
    s_add_u32 m0, m0, 1024
    s_nop 0
    buffer_load_dwordx4 v28, s[20:23], s49 offen lds
    s_sub_u32 s59, 4, s43
    s_and_b32 s59, s59, 7
    s_lshl_b32 s59, s59, 2
    s_lshr_b32 s59, 0x75364210, s59
    s_lshl_b32 s49, s46, 1
    s_add_u32 s59, s59, s49
    s_and_b32 s59, s59, 7
    s_mul_i32 s59, s59, 81920
    s_add_u32 s59, s59, s58
    s_add_u32 m0, s61, 61440
    s_add_u32 s49, s59, 0
    buffer_load_dwordx4 v24, s[20:23], s49 offen lds
    s_add_u32 m0, m0, 1024
    s_nop 0
    buffer_load_dwordx4 v25, s[20:23], s49 offen lds
    s_add_u32 m0, m0, 1024
    s_nop 0
    buffer_load_dwordx4 v26, s[20:23], s49 offen lds
    s_add_u32 m0, m0, 1024
    s_nop 0
    buffer_load_dwordx4 v27, s[20:23], s49 offen lds
    s_add_u32 m0, m0, 1024
    s_nop 0
    buffer_load_dwordx4 v28, s[20:23], s49 offen lds
    s_waitcnt vmcnt(25)
    s_barrier
    s_add_u32 m0, s61, 71680
    s_add_u32 s49, s59, 40960
    buffer_load_dwordx4 v24, s[20:23], s49 offen lds
    s_add_u32 m0, m0, 1024
    s_nop 0
    buffer_load_dwordx4 v25, s[20:23], s49 offen lds
    s_add_u32 m0, m0, 1024
    s_nop 0
    buffer_load_dwordx4 v26, s[20:23], s49 offen lds
    s_add_u32 m0, m0, 1024
    s_nop 0
    buffer_load_dwordx4 v27, s[20:23], s49 offen lds
    s_add_u32 m0, m0, 1024
    s_nop 0
    buffer_load_dwordx4 v28, s[20:23], s49 offen lds
    s_sub_u32 s59, 5, s43
    s_and_b32 s59, s59, 7
    s_lshl_b32 s59, s59, 2
    s_lshr_b32 s59, 0x75364210, s59
    s_lshl_b32 s49, s46, 1
    s_add_u32 s59, s59, s49
    s_and_b32 s59, s59, 7
    s_mul_i32 s59, s59, 81920
    s_add_u32 s59, s59, s58
    s_add_u32 m0, s61, 40960
    s_add_u32 s49, s59, 0
    buffer_load_dwordx4 v24, s[20:23], s49 offen lds
    s_add_u32 m0, m0, 1024
    s_nop 0
    buffer_load_dwordx4 v25, s[20:23], s49 offen lds
    s_add_u32 m0, m0, 1024
    s_nop 0
    buffer_load_dwordx4 v26, s[20:23], s49 offen lds
    s_add_u32 m0, m0, 1024
    s_nop 0
    buffer_load_dwordx4 v27, s[20:23], s49 offen lds
    s_add_u32 m0, m0, 1024
    s_nop 0
    buffer_load_dwordx4 v28, s[20:23], s49 offen lds
    s_add_u32 m0, s61, 51200
    s_add_u32 s49, s59, 40960
    buffer_load_dwordx4 v24, s[20:23], s49 offen lds
    s_add_u32 m0, m0, 1024
    s_nop 0
    buffer_load_dwordx4 v25, s[20:23], s49 offen lds
    s_add_u32 m0, m0, 1024
    s_nop 0
    buffer_load_dwordx4 v26, s[20:23], s49 offen lds
    s_add_u32 m0, m0, 1024
    s_nop 0
    buffer_load_dwordx4 v27, s[20:23], s49 offen lds
    s_add_u32 m0, m0, 1024
    s_nop 0
    buffer_load_dwordx4 v28, s[20:23], s49 offen lds
    s_sub_u32 s59, 6, s43
    s_and_b32 s59, s59, 7
    s_lshl_b32 s59, s59, 2
    s_lshr_b32 s59, 0x75364210, s59
    s_lshl_b32 s49, s46, 1
    s_add_u32 s59, s59, s49
    s_and_b32 s59, s59, 7
    s_mul_i32 s59, s59, 81920
    s_add_u32 s59, s59, s58
    s_add_u32 m0, s61, 20480
    s_add_u32 s49, s59, 0
    buffer_load_dwordx4 v24, s[20:23], s49 offen lds
    s_add_u32 m0, m0, 1024
    s_nop 0
    buffer_load_dwordx4 v25, s[20:23], s49 offen lds
    s_add_u32 m0, m0, 1024
    s_nop 0
    buffer_load_dwordx4 v26, s[20:23], s49 offen lds
    s_add_u32 m0, m0, 1024
    s_nop 0
    buffer_load_dwordx4 v27, s[20:23], s49 offen lds
    s_add_u32 m0, m0, 1024
    s_nop 0
    buffer_load_dwordx4 v28, s[20:23], s49 offen lds
    s_add_u32 m0, s61, 30720
    s_add_u32 s49, s59, 40960
    buffer_load_dwordx4 v24, s[20:23], s49 offen lds
    s_add_u32 m0, m0, 1024
    s_nop 0
    buffer_load_dwordx4 v25, s[20:23], s49 offen lds
    s_add_u32 m0, m0, 1024
    s_nop 0
    buffer_load_dwordx4 v26, s[20:23], s49 offen lds
    s_add_u32 m0, m0, 1024
    s_nop 0
    buffer_load_dwordx4 v27, s[20:23], s49 offen lds
    s_add_u32 m0, m0, 1024
    s_nop 0
    buffer_load_dwordx4 v28, s[20:23], s49 offen lds
    s_sub_u32 s59, 7, s43
    s_and_b32 s59, s59, 7
    s_lshl_b32 s59, s59, 2
    s_lshr_b32 s59, 0x75364210, s59
    s_lshl_b32 s49, s46, 1
    s_add_u32 s59, s59, s49
    s_and_b32 s59, s59, 7
    s_mul_i32 s59, s59, 81920
    s_add_u32 s59, s59, s58
    s_add_u32 m0, s61, 0
    s_add_u32 s49, s59, 0
    buffer_load_dwordx4 v24, s[20:23], s49 offen lds
    s_add_u32 m0, m0, 1024
    s_nop 0
    buffer_load_dwordx4 v25, s[20:23], s49 offen lds
    s_add_u32 m0, m0, 1024
    s_nop 0
    buffer_load_dwordx4 v26, s[20:23], s49 offen lds
    s_add_u32 m0, m0, 1024
    s_nop 0
    buffer_load_dwordx4 v27, s[20:23], s49 offen lds
    s_add_u32 m0, m0, 1024
    s_nop 0
    buffer_load_dwordx4 v28, s[20:23], s49 offen lds
    s_add_u32 m0, s61, 10240
    s_add_u32 s49, s59, 40960
    buffer_load_dwordx4 v24, s[20:23], s49 offen lds
    s_add_u32 m0, m0, 1024
    s_nop 0
    buffer_load_dwordx4 v25, s[20:23], s49 offen lds
    s_add_u32 m0, m0, 1024
    s_nop 0
    buffer_load_dwordx4 v26, s[20:23], s49 offen lds
    s_add_u32 m0, m0, 1024
    s_nop 0
    buffer_load_dwordx4 v27, s[20:23], s49 offen lds
    s_add_u32 m0, m0, 1024
    s_nop 0
    buffer_load_dwordx4 v28, s[20:23], s49 offen lds
    s_waitcnt vmcnt(0)
    s_barrier
    s_branch L_fin
L_aux:
    s_cmp_eq_u32 s3, 6
    s_cbranch_scc1 L_prep
    s_mov_b32 s59, 1
    s_mov_b32 s61, 1
    s_barrier
L_16:
    s_cmp_eq_u32 s61, 0
    s_cbranch_scc1 L_17
    s_mov_b32 s60, 0
L_18:
    s_getreg_b32 s49, hwreg(HW_REG_IB_STS, 0, 4)
    s_cmp_eq_u32 s49, 0
    s_cbranch_scc1 L_19
    s_cmp_eq_u32 s59, 3
    s_cbranch_scc1 L_19
    s_sleep 1
    s_add_u32 s60, s60, 1
    s_cmp_lt_u32 s60, 4
    s_cbranch_scc1 L_18
    s_branch L_17
L_19:
    s_mov_b32 s61, 0
    s_mov_b32 s40, 0
    s_branch nonc_22
non_20:
    buffer_load_dwordx2 v[14:15], off, s[28:31], 0 sc1
nonc_22:
    s_waitcnt vmcnt(0)
    v_readfirstlane_b32 s6, v14
    v_readfirstlane_b32 s7, v15
    s_add_u32 s40, s40, 1
    s_cmp_lg_u32 s6, 0
    s_cbranch_scc1 nonx_21
    s_sleep 1
    s_cmp_lt_u32 s40, 400000
    s_cbranch_scc1 non_20
nonx_21:
    s_lshr_b32 s48, s41, 1
    s_lshl_b32 s48, s48, 8
    s_and_b32 s62, s41, 1
    s_lshl_b32 s62, s62, 6
    s_add_u32 s48, s48, s62
    s_add_u32 s48, s48, 24772608
    v_and_b32 v8, 3, v1
    v_lshlrev_b32 v8, 4, v8
    v_lshrrev_b32 v9, 2, v1
    v_lshl_add_u32 v8, v9, 7, v8
    v_mov_b32 v57, s6
    v_mov_b32 v59, s6
    s_mov_b64 exec, 0xff
    buffer_store_dwordx4 v[56:59], v8, s[12:15], s48 offen sc1
    s_mov_b64 exec, -1
    s_lshl_b32 s49, s4, 3
    s_and_b32 s40, s5, 7
    s_add_u32 s49, s49, s40
    s_lshl_b32 s49, s49, 9
    s_and_b32 s40, s5, 24
    s_lshl_b32 s40, s40, 4
    s_add_u32 s49, s49, s40
    s_add_u32 s49, s49, 16256
    v_lshlrev_b32 v12, 3, v1
    v_add_u32 v12, s49, v12
    s_lshl_b32 s49, s41, 3
    s_mov_b64 exec, 0xff
    v_lshlrev_b32 v12, 11, v1
    v_add_u32 v12, s49, v12
    s_mov_b64 exec, -1
    s_mov_b32 s49, 25001984
    v_mov_b32 v14, s6
    v_mov_b32 v15, s7
    s_mov_b64 exec, 0xffff00ff
    buffer_store_dwordx2 v[14:15], v12, s[12:15], s49 offen offset:0 sc1
    s_mov_b64 exec, -1
L_17:
    s_barrier
    s_add_u32 s59, s59, 1
    s_cmp_lt_i32 s59, 12
    s_cbranch_scc1 L_16
    s_branch L_fin
L_prep:
    s_mov_b32 s20, s74
    s_and_b32 s21, s75, 0xffff
    s_mov_b32 s22, 0xc00
    s_mov_b32 s23, 0x00020000
    v_lshlrev_b32 v20, 4, v1
    v_lshlrev_b32 v21, 2, v1
    v_lshlrev_b32 v22, 7, v1
    s_lshl_b32 s58, s47, 14
    s_add_u32 s58, s58, 24805376
    s_lshl_b32 s59, s44, 11
    s_add_u32 s59, s59, 24772608
    s_lshl_b32 s60, s45, 4
    s_add_u32 s60, s60, s44
    s_lshl_b32 s60, s60, 9
    s_add_u32 s60, s60, 25133056
    s_lshl_b32 s49, s47, 8
    s_barrier
    buffer_load_dwordx2 v[14:15], off, s[28:31], 0 sc1
    s_mov_b32 s56, 0x00003f80
    s_mov_b32 s57, 0x3f800000
    v_and_b32 v9, 15, v1
    v_lshlrev_b32 v9, 6, v9
    v_lshrrev_b32 v10, 4, v1
    v_lshl_add_u32 v9, v10, 4, v9
    s_lshl_b32 s61, s44, 10
    s_add_u32 s61, s61, s58
    v_mov_b32 v24, 0
    v_mov_b32 v25, 0
    v_mov_b32 v26, 0
    v_mov_b32 v27, 0
    v_mov_b32 v28, 0
    v_mov_b32 v29, 0
    v_mov_b32 v30, 0
    v_mov_b32 v31, 0
    s_waitcnt vmcnt(1)
    v_dot2c_f32_bf16 v24, s56, v108
    v_dot2c_f32_bf16 v25, s57, v108
    v_dot2c_f32_bf16 v26, s56, v109
    v_dot2c_f32_bf16 v27, s57, v109
    v_dot2c_f32_bf16 v28, s56, v110
    v_dot2c_f32_bf16 v29, s57, v110
    v_dot2c_f32_bf16 v30, s56, v111
    v_dot2c_f32_bf16 v31, s57, v111
    v_dot2c_f32_bf16 v24, s56, v112
    v_dot2c_f32_bf16 v25, s57, v112
    v_dot2c_f32_bf16 v26, s56, v113
    v_dot2c_f32_bf16 v27, s57, v113
    v_dot2c_f32_bf16 v28, s56, v114
    v_dot2c_f32_bf16 v29, s57, v114
    v_dot2c_f32_bf16 v30, s56, v115
    v_dot2c_f32_bf16 v31, s57, v115
    v_dot2c_f32_bf16 v24, s56, v116
    v_dot2c_f32_bf16 v25, s57, v116
    v_dot2c_f32_bf16 v26, s56, v117
    v_dot2c_f32_bf16 v27, s57, v117
    v_dot2c_f32_bf16 v28, s56, v118
    v_dot2c_f32_bf16 v29, s57, v118
    v_dot2c_f32_bf16 v30, s56, v119
    v_dot2c_f32_bf16 v31, s57, v119
    v_dot2c_f32_bf16 v24, s56, v120
    v_dot2c_f32_bf16 v25, s57, v120
    v_dot2c_f32_bf16 v26, s56, v121
    v_dot2c_f32_bf16 v27, s57, v121
    v_dot2c_f32_bf16 v28, s56, v122
    v_dot2c_f32_bf16 v29, s57, v122
    v_dot2c_f32_bf16 v30, s56, v123
    v_dot2c_f32_bf16 v31, s57, v123
    v_dot2c_f32_bf16 v24, s56, v124
    v_dot2c_f32_bf16 v25, s57, v124
    v_dot2c_f32_bf16 v26, s56, v125
    v_dot2c_f32_bf16 v27, s57, v125
    v_dot2c_f32_bf16 v28, s56, v126
    v_dot2c_f32_bf16 v29, s57, v126
    v_dot2c_f32_bf16 v30, s56, v127
    v_dot2c_f32_bf16 v31, s57, v127
    v_dot2c_f32_bf16 v24, s56, v128
    v_dot2c_f32_bf16 v25, s57, v128
    v_dot2c_f32_bf16 v26, s56, v129
    v_dot2c_f32_bf16 v27, s57, v129
    v_dot2c_f32_bf16 v28, s56, v130
    v_dot2c_f32_bf16 v29, s57, v130
    v_dot2c_f32_bf16 v30, s56, v131
    v_dot2c_f32_bf16 v31, s57, v131
    v_dot2c_f32_bf16 v24, s56, v132
    v_dot2c_f32_bf16 v25, s57, v132
    v_dot2c_f32_bf16 v26, s56, v133
    v_dot2c_f32_bf16 v27, s57, v133
    v_dot2c_f32_bf16 v28, s56, v134
    v_dot2c_f32_bf16 v29, s57, v134
    v_dot2c_f32_bf16 v30, s56, v135
    v_dot2c_f32_bf16 v31, s57, v135
    v_dot2c_f32_bf16 v24, s56, v136
    v_dot2c_f32_bf16 v25, s57, v136
    v_dot2c_f32_bf16 v26, s56, v137
    v_dot2c_f32_bf16 v27, s57, v137
    v_dot2c_f32_bf16 v28, s56, v138
    v_dot2c_f32_bf16 v29, s57, v138
    v_dot2c_f32_bf16 v30, s56, v139
    v_dot2c_f32_bf16 v31, s57, v139
    v_dot2c_f32_bf16 v24, s56, v140
    v_dot2c_f32_bf16 v25, s57, v140
    v_dot2c_f32_bf16 v26, s56, v141
    v_dot2c_f32_bf16 v27, s57, v141
    v_dot2c_f32_bf16 v28, s56, v142
    v_dot2c_f32_bf16 v29, s57, v142
    v_dot2c_f32_bf16 v30, s56, v143
    v_dot2c_f32_bf16 v31, s57, v143
    v_dot2c_f32_bf16 v24, s56, v144
    v_dot2c_f32_bf16 v25, s57, v144
    v_dot2c_f32_bf16 v26, s56, v145
    v_dot2c_f32_bf16 v27, s57, v145
    v_dot2c_f32_bf16 v28, s56, v146
    v_dot2c_f32_bf16 v29, s57, v146
    v_dot2c_f32_bf16 v30, s56, v147
    v_dot2c_f32_bf16 v31, s57, v147
    v_permlane32_swap_b32 v24, v28
    v_permlane32_swap_b32 v25, v29
    v_permlane32_swap_b32 v26, v30
    v_permlane32_swap_b32 v27, v31
    v_add_f32 v24, v24, v28
    v_add_f32 v25, v25, v29
    v_add_f32 v26, v26, v30
    v_add_f32 v27, v27, v31
    s_nop 0
    v_permlane16_swap_b32 v24, v26
    v_permlane16_swap_b32 v25, v27
    v_add_f32 v24, v24, v26
    v_add_f32 v26, v25, v27
    s_barrier
    s_mov_b32 s40, 0
    s_branch nonc_25
non_23:
    buffer_load_dwordx2 v[14:15], off, s[28:31], 0 sc1
nonc_25:
    s_waitcnt vmcnt(0)
    v_readfirstlane_b32 s6, v14
    v_readfirstlane_b32 s7, v15
    s_add_u32 s40, s40, 1
    s_cmp_lg_u32 s6, 0
    s_cbranch_scc1 nonx_24
    s_sleep 1
    s_cmp_lt_u32 s40, 400000
    s_cbranch_scc1 non_23
nonx_24:
    v_mov_b32 v25, s6
    v_mov_b32 v27, s6
    buffer_store_dwordx4 v[24:27], v9, s[12:15], s61 offen sc1
    s_barrier
    s_barrier
    s_barrier
    s_barrier
    buffer_load_dword v96, v21, s[20:23], s49 offen
    s_sleep 0
    s_add_u32 s61, s58, 0
    buffer_load_dwordx4 v[24:27], v20, s[12:15], s61 offen offset:0 sc1
    buffer_load_dwordx4 v[28:31], v20, s[12:15], s61 offen offset:1024 sc1
    buffer_load_dwordx4 v[32:35], v20, s[12:15], s61 offen offset:2048 sc1
    buffer_load_dwordx4 v[36:39], v20, s[12:15], s61 offen offset:3072 sc1
    s_add_u32 s61, s58, 4096
    buffer_load_dwordx4 v[40:43], v20, s[12:15], s61 offen offset:0 sc1
    buffer_load_dwordx4 v[44:47], v20, s[12:15], s61 offen offset:1024 sc1
    buffer_load_dwordx4 v[48:51], v20, s[12:15], s61 offen offset:2048 sc1
    buffer_load_dwordx4 v[52:55], v20, s[12:15], s61 offen offset:3072 sc1
    s_add_u32 s61, s58, 8192
    buffer_load_dwordx4 v[56:59], v20, s[12:15], s61 offen offset:0 sc1
    buffer_load_dwordx4 v[60:63], v20, s[12:15], s61 offen offset:1024 sc1
    buffer_load_dwordx4 v[64:67], v20, s[12:15], s61 offen offset:2048 sc1
    buffer_load_dwordx4 v[68:71], v20, s[12:15], s61 offen offset:3072 sc1
    s_add_u32 s61, s58, 12288
    buffer_load_dwordx4 v[72:75], v20, s[12:15], s61 offen offset:0 sc1
    buffer_load_dwordx4 v[76:79], v20, s[12:15], s61 offen offset:1024 sc1
    buffer_load_dwordx4 v[80:83], v20, s[12:15], s61 offen offset:2048 sc1
    buffer_load_dwordx4 v[84:87], v20, s[12:15], s61 offen offset:3072 sc1
    buffer_load_dwordx4 v[88:91], v20, s[12:15], s59 offen offset:0 sc1
    buffer_load_dwordx4 v[92:95], v20, s[12:15], s59 offen offset:1024 sc1
    s_barrier
    s_mov_b32 s40, 0
L_26:
    s_waitcnt vmcnt(0)
    v_min_u32 v8, v25, v27
    v_max_u32 v9, v25, v27
    v_min3_u32 v8, v8, v29, v31
    v_max3_u32 v9, v9, v29, v31
    v_min3_u32 v8, v8, v33, v35
    v_max3_u32 v9, v9, v33, v35
    v_min3_u32 v8, v8, v37, v39
    v_max3_u32 v9, v9, v37, v39
    v_min3_u32 v8, v8, v41, v43
    v_max3_u32 v9, v9, v41, v43
    v_min3_u32 v8, v8, v45, v47
    v_max3_u32 v9, v9, v45, v47
    v_min3_u32 v8, v8, v49, v51
    v_max3_u32 v9, v9, v49, v51
    v_min3_u32 v8, v8, v53, v55
    v_max3_u32 v9, v9, v53, v55
    v_min3_u32 v8, v8, v57, v59
    v_max3_u32 v9, v9, v57, v59
    v_min3_u32 v8, v8, v61, v63
    v_max3_u32 v9, v9, v61, v63
    v_min3_u32 v8, v8, v65, v67
    v_max3_u32 v9, v9, v65, v67
    v_min3_u32 v8, v8, v69, v71
    v_max3_u32 v9, v9, v69, v71
    v_min3_u32 v8, v8, v73, v75
    v_max3_u32 v9, v9, v73, v75
    v_min3_u32 v8, v8, v77, v79
    v_max3_u32 v9, v9, v77, v79
    v_min3_u32 v8, v8, v81, v83
    v_max3_u32 v9, v9, v81, v83
    v_min3_u32 v8, v8, v85, v87
    v_max3_u32 v9, v9, v85, v87
    v_min3_u32 v8, v8, v89, v91
    v_max3_u32 v9, v9, v89, v91
    v_min3_u32 v8, v8, v93, v95
    v_max3_u32 v9, v9, v93, v95
    v_cmp_ne_u32 vcc, s6, v8
    v_cmp_ne_u32 s[56:57], s6, v9
    s_nop 0
    s_or_b64 vcc, vcc, s[56:57]
    s_cbranch_vccz L_27
    s_add_u32 s40, s40, 1
    s_cmp_ge_u32 s40, 400000
    s_cbranch_scc1 L_27
    s_add_u32 s61, s58, 0
    buffer_load_dwordx4 v[24:27], v20, s[12:15], s61 offen offset:0 sc1
    buffer_load_dwordx4 v[28:31], v20, s[12:15], s61 offen offset:1024 sc1
    buffer_load_dwordx4 v[32:35], v20, s[12:15], s61 offen offset:2048 sc1
    buffer_load_dwordx4 v[36:39], v20, s[12:15], s61 offen offset:3072 sc1
    s_add_u32 s61, s58, 4096
    buffer_load_dwordx4 v[40:43], v20, s[12:15], s61 offen offset:0 sc1
    buffer_load_dwordx4 v[44:47], v20, s[12:15], s61 offen offset:1024 sc1
    buffer_load_dwordx4 v[48:51], v20, s[12:15], s61 offen offset:2048 sc1
    buffer_load_dwordx4 v[52:55], v20, s[12:15], s61 offen offset:3072 sc1
    s_add_u32 s61, s58, 8192
    buffer_load_dwordx4 v[56:59], v20, s[12:15], s61 offen offset:0 sc1
    buffer_load_dwordx4 v[60:63], v20, s[12:15], s61 offen offset:1024 sc1
    buffer_load_dwordx4 v[64:67], v20, s[12:15], s61 offen offset:2048 sc1
    buffer_load_dwordx4 v[68:71], v20, s[12:15], s61 offen offset:3072 sc1
    s_add_u32 s61, s58, 12288
    buffer_load_dwordx4 v[72:75], v20, s[12:15], s61 offen offset:0 sc1
    buffer_load_dwordx4 v[76:79], v20, s[12:15], s61 offen offset:1024 sc1
    buffer_load_dwordx4 v[80:83], v20, s[12:15], s61 offen offset:2048 sc1
    buffer_load_dwordx4 v[84:87], v20, s[12:15], s61 offen offset:3072 sc1
    buffer_load_dwordx4 v[88:91], v20, s[12:15], s59 offen offset:0 sc1
    buffer_load_dwordx4 v[92:95], v20, s[12:15], s59 offen offset:1024 sc1
    s_branch L_26
L_27:
    v_add_f32 v24, v24, v56
    v_add_f32 v26, v26, v58
    v_add_f32 v28, v28, v60
    v_add_f32 v30, v30, v62
    v_add_f32 v32, v32, v64
    v_add_f32 v34, v34, v66
    v_add_f32 v36, v36, v68
    v_add_f32 v38, v38, v70
    v_add_f32 v40, v40, v72
    v_add_f32 v42, v42, v74
    v_add_f32 v44, v44, v76
    v_add_f32 v46, v46, v78
    v_add_f32 v48, v48, v80
    v_add_f32 v50, v50, v82
    v_add_f32 v52, v52, v84
    v_add_f32 v54, v54, v86
    v_add_f32 v24, v24, v40
    v_add_f32 v26, v26, v42
    v_add_f32 v28, v28, v44
    v_add_f32 v30, v30, v46
    v_add_f32 v32, v32, v48
    v_add_f32 v34, v34, v50
    v_add_f32 v36, v36, v52
    v_add_f32 v38, v38, v54
    v_add_f32 v24, v24, v32
    v_add_f32 v26, v26, v34
    v_add_f32 v28, v28, v36
    v_add_f32 v30, v30, v38
    v_add_f32 v24, v24, v28
    v_add_f32 v26, v26, v30
    v_lshlrev_b32 v25, 16, v96
    v_and_b32 v27, 0xffff0000, v96
    v_lshlrev_b32 v21, 5, v1
    v_add_u32 v21, 131072, v21
    v_add_u32 v20, 131072, v20
    v_cvt_pk_bf16_f32 v100, v24, v24
    v_lshlrev_b32 v8, 16, v100
    v_sub_f32 v8, v24, v8
    v_cvt_pk_bf16_f32 v101, v8, v25
    v_cvt_pk_bf16_f32 v102, v25, 0
    v_mov_b32 v103, 0
    ds_write_b128 v21, v[100:103] offset:0
    v_cvt_pk_bf16_f32 v104, v26, v26
    v_lshlrev_b32 v8, 16, v104
    v_sub_f32 v8, v26, v8
    v_cvt_pk_bf16_f32 v105, v8, v27
    v_cvt_pk_bf16_f32 v106, v27, 0
    v_mov_b32 v107, 0
    ds_write_b128 v21, v[104:107] offset:16
    s_barrier
    v_cvt_pk_bf16_f32 v109, -v88, v90
    v_rcp_f32 v115, v90
    v_lshlrev_b32 v8, 16, v109
    v_and_b32 v9, 0xffff0000, v109
    v_sub_f32 v9, v90, v9
    v_add_f32 v88, v88, v8
    v_cvt_pk_bf16_f32 v108, v8, -v88
    v_cvt_pk_bf16_f32 v110, v9, 0
    v_mov_b32 v111, 0
    v_mul_f32 v112, 0xc0135761, v115
    v_mul_f32 v9, v115, v115
    v_mul_f32 v9, v9, v115
    v_mul_f32 v113, 0xbdd2d3e8, v9
    v_mov_b32 v114, v90
    ds_write_b128 v20, v[108:111] offset:2048
    ds_write_b128 v20, v[112:115] offset:4096
    v_cvt_pk_bf16_f32 v117, -v92, v94
    v_rcp_f32 v123, v94
    v_lshlrev_b32 v8, 16, v117
    v_and_b32 v9, 0xffff0000, v117
    v_sub_f32 v9, v94, v9
    v_add_f32 v92, v92, v8
    v_cvt_pk_bf16_f32 v116, v8, -v92
    v_cvt_pk_bf16_f32 v118, v9, 0
    v_mov_b32 v119, 0
    v_mul_f32 v120, 0xc0135761, v123
    v_mul_f32 v9, v123, v123
    v_mul_f32 v9, v9, v123
    v_mul_f32 v121, 0xbdd2d3e8, v9
    v_mov_b32 v122, v94
    ds_write_b128 v20, v[116:119] offset:3072
    ds_write_b128 v20, v[120:123] offset:5120
    v_mov_b32 v8, 0
    v_mov_b32 v9, 0
    v_mov_b32 v10, 0
    v_mov_b32 v11, 0
    v_mov_b32 v21, 137216
    ds_write_b128 v21, v[8:11]
    ds_write_b64 v21, v[14:15] offset:16
    s_waitcnt lgkmcnt(0)
    s_barrier
    s_barrier
    s_barrier
    s_barrier
    s_barrier
    s_branch L_fin
L_Gc:
    s_setprio 0
    s_mov_b32 s12, s84
    s_and_b32 s13, s85, 0xffff
    s_mov_b32 s14, 0x1848000
    s_mov_b32 s15, 0x00020000
    v_mov_b32 v60, 0
    v_mov_b32 v61, 0
    v_mov_b32 v62, 0
    v_mov_b32 v63, 0
    s_nop 1
    v_mfma_f32_32x32x16_bf16 v[144:159], v[60:63], v[60:63], 0
    v_bfe_u32 v57, v2, 1, 3
    v_xor_b32 v57, v57, v3
    v_lshlrev_b32 v57, 4, v57
    v_lshl_add_u32 v57, v2, 7, v57
    s_lshl_b32 s48, s3, 12
    s_add_u32 s48, s48, 32768
    v_add_u32 v4, s48, v57
    v_bfe_u32 v58, v1, 2, 2
    v_lshl_add_u32 v57, v3, 3, v58
    v_lshlrev_b32 v57, 8, v57
    v_bfe_u32 v59, v1, 4, 1
    v_lshl_add_u32 v57, v59, 5, v57
    v_and_b32 v59, 3, v1
    v_mfma_f32_32x32x16_bf16 v[160:175], v[60:63], v[60:63], 0
    v_lshl_add_u32 v57, v59, 3, v57
    v_add_u32 v57, 16384, v57
    v_xor_b32 v59, 0, v58
    v_lshl_add_u32 v5, v59, 6, v57
    v_xor_b32 v59, 1, v58
    v_lshl_add_u32 v6, v59, 6, v57
    v_xor_b32 v59, 2, v58
    v_lshl_add_u32 v7, v59, 6, v57
    v_xor_b32 v59, 3, v58
    v_lshl_add_u32 v8, v59, 6, v57
    v_lshlrev_b32 v13, 4, v2
    v_lshlrev_b32 v12, 4, v1
    s_mov_b32 s49, 0
    v_mfma_f32_32x32x16_bf16 v[176:191], v[60:63], v[60:63], 0
    v_add_u32 v9, 131072, v13
    s_lshl_b32 s48, s3, 9
    v_add_u32 v11, s48, v9
    v_mov_b32 v10, 135168
    v_cmp_eq_u32 vcc, 0, v3
    s_nop 1
    v_cndmask_b32 v10, v10, v11, vcc
    s_lshl_b32 s50, s44, 2
    s_add_u32 s50, s50, s3
    s_lshl_b32 s53, s45, 6
    s_add_u32 s53, s53, s50
    s_lshl_b32 s53, s53, 10
    s_add_u32 s53, s53, 25133056
    s_mul_i32 s50, s50, 3
    v_mfma_f32_32x32x16_bf16 v[192:207], v[60:63], v[60:63], 0
    s_add_u32 s50, s50, s45
    s_mul_i32 s50, s50, 32768
    s_add_u32 s50, s50, 9043968
    s_mul_i32 s51, s46, 8192
    s_add_u32 s51, s51, s50
    s_lshl_b32 s52, s45, 8
    s_lshl_b32 s48, s44, 4
    s_add_u32 s52, s52, s48
    s_lshl_b32 s48, s3, 2
    s_add_u32 s52, s52, s48
    s_mul_i32 s52, s52, 10240
    s_mul_i32 s48, s46, 2560
    s_add_u32 s52, s52, s48
    s_add_u32 s52, s52, 16908288
    s_waitcnt vmcnt(8)
    s_barrier
    ds_read_b64_tr_b16 v[24:25], v5 offset:32768
    ds_read_b64_tr_b16 v[26:27], v5 offset:33792
    ds_read_b64_tr_b16 v[28:29], v6 offset:32768
    ds_read_b64_tr_b16 v[30:31], v6 offset:33792
    ds_read_b128 v[16:19], v4
    ds_read_b64_tr_b16 v[32:33], v7 offset:32768
    ds_read_b64_tr_b16 v[34:35], v7 offset:33792
    ds_read_b64_tr_b16 v[36:37], v8 offset:32768
    ds_read_b64_tr_b16 v[38:39], v8 offset:33792
    v_xor_b32 v4, 0x20, v4
    ds_read_b64_tr_b16 v[40:41], v5 offset:36864
    ds_read_b64_tr_b16 v[42:43], v5 offset:37888
    ds_read_b64_tr_b16 v[44:45], v6 offset:36864
    ds_read_b64_tr_b16 v[46:47], v6 offset:37888
    ds_read_b128 v[20:23], v4
    ds_read_b64_tr_b16 v[48:49], v7 offset:36864
    s_waitcnt lgkmcnt(14)
    ds_read_b64_tr_b16 v[50:51], v7 offset:37888
g1_28:
    s_waitcnt lgkmcnt(11)
    v_mfma_f32_32x32x16_bf16 v[144:159], v[24:27], v[16:19], v[144:159]
    ds_read_b64_tr_b16 v[52:53], v8 offset:36864
    ds_read_b64_tr_b16 v[54:55], v8 offset:37888
    v_xor_b32 v4, 0x60, v4
    v_mfma_f32_32x32x16_bf16 v[160:175], v[28:31], v[16:19], v[160:175]
    ds_read_b64_tr_b16 v[24:25], v5 offset:40960
    ds_read_b64_tr_b16 v[26:27], v5 offset:41984
    s_waitcnt lgkmcnt(13)
    v_mfma_f32_32x32x16_bf16 v[176:191], v[32:35], v[16:19], v[176:191]
    ds_read_b64_tr_b16 v[28:29], v6 offset:40960
    ds_read_b64_tr_b16 v[30:31], v6 offset:41984
    s_waitcnt lgkmcnt(13)
    v_mfma_f32_32x32x16_bf16 v[192:207], v[36:39], v[16:19], v[192:207]
    ds_read_b128 v[16:19], v4
    ds_read_b64_tr_b16 v[32:33], v7 offset:40960
    s_waitcnt lgkmcnt(14)
    ds_read_b64_tr_b16 v[34:35], v7 offset:41984
    s_waitcnt lgkmcnt(11)
    v_mfma_f32_32x32x16_bf16 v[144:159], v[40:43], v[20:23], v[144:159]
    ds_read_b64_tr_b16 v[36:37], v8 offset:40960
    ds_read_b64_tr_b16 v[38:39], v8 offset:41984
    v_xor_b32 v4, 0x20, v4
    v_mfma_f32_32x32x16_bf16 v[160:175], v[44:47], v[20:23], v[160:175]
    ds_read_b64_tr_b16 v[40:41], v5 offset:45056
    ds_read_b64_tr_b16 v[42:43], v5 offset:46080
    s_waitcnt lgkmcnt(13)
    v_mfma_f32_32x32x16_bf16 v[176:191], v[48:51], v[20:23], v[176:191]
    ds_read_b64_tr_b16 v[44:45], v6 offset:45056
    ds_read_b64_tr_b16 v[46:47], v6 offset:46080
    s_waitcnt lgkmcnt(13)
    v_mfma_f32_32x32x16_bf16 v[192:207], v[52:55], v[20:23], v[192:207]
    ds_read_b128 v[20:23], v4
    ds_read_b64_tr_b16 v[48:49], v7 offset:45056
    s_waitcnt lgkmcnt(14)
    ds_read_b64_tr_b16 v[50:51], v7 offset:46080
    s_waitcnt lgkmcnt(11)
    v_mfma_f32_32x32x16_bf16 v[144:159], v[24:27], v[16:19], v[144:159]
    ds_read_b64_tr_b16 v[52:53], v8 offset:45056
    ds_read_b64_tr_b16 v[54:55], v8 offset:46080
    v_xor_b32 v4, 0x8060, v4
    v_mfma_f32_32x32x16_bf16 v[160:175], v[28:31], v[16:19], v[160:175]
    ds_read_b64_tr_b16 v[24:25], v5 offset:0
    ds_read_b64_tr_b16 v[26:27], v5 offset:1024
    s_waitcnt lgkmcnt(13)
    v_mfma_f32_32x32x16_bf16 v[176:191], v[32:35], v[16:19], v[176:191]
    ds_read_b64_tr_b16 v[28:29], v6 offset:0
    ds_read_b64_tr_b16 v[30:31], v6 offset:1024
    s_waitcnt lgkmcnt(13)
    v_mfma_f32_32x32x16_bf16 v[192:207], v[36:39], v[16:19], v[192:207]
    ds_read_b128 v[16:19], v4
    ds_read_b64_tr_b16 v[32:33], v7 offset:0
    s_waitcnt lgkmcnt(14)
    ds_read_b64_tr_b16 v[34:35], v7 offset:1024
    s_waitcnt lgkmcnt(11)
    v_mfma_f32_32x32x16_bf16 v[144:159], v[40:43], v[20:23], v[144:159]
    ds_read_b64_tr_b16 v[36:37], v8 offset:0
    ds_read_b64_tr_b16 v[38:39], v8 offset:1024
    v_xor_b32 v4, 0x20, v4
    v_mfma_f32_32x32x16_bf16 v[160:175], v[44:47], v[20:23], v[160:175]
    ds_read_b64_tr_b16 v[40:41], v5 offset:4096
    ds_read_b64_tr_b16 v[42:43], v5 offset:5120
    s_waitcnt lgkmcnt(13)
    v_mfma_f32_32x32x16_bf16 v[176:191], v[48:51], v[20:23], v[176:191]
    ds_read_b64_tr_b16 v[44:45], v6 offset:4096
    ds_read_b64_tr_b16 v[46:47], v6 offset:5120
    s_waitcnt lgkmcnt(13)
    v_mfma_f32_32x32x16_bf16 v[192:207], v[52:55], v[20:23], v[192:207]
    s_waitcnt vmcnt(0)
    s_barrier
    ds_read_b128 v[20:23], v4
    ds_read_b64_tr_b16 v[48:49], v7 offset:4096
    s_waitcnt lgkmcnt(14)
    ds_read_b64_tr_b16 v[50:51], v7 offset:5120
    s_waitcnt lgkmcnt(11)
    v_mfma_f32_32x32x16_bf16 v[144:159], v[24:27], v[16:19], v[144:159]
    ds_read_b64_tr_b16 v[52:53], v8 offset:4096
    ds_read_b64_tr_b16 v[54:55], v8 offset:5120
    v_xor_b32 v4, 0x60, v4
    v_mfma_f32_32x32x16_bf16 v[160:175], v[28:31], v[16:19], v[160:175]
    ds_read_b64_tr_b16 v[24:25], v5 offset:8192
    ds_read_b64_tr_b16 v[26:27], v5 offset:9216
    s_waitcnt lgkmcnt(13)
    v_mfma_f32_32x32x16_bf16 v[176:191], v[32:35], v[16:19], v[176:191]
    ds_read_b64_tr_b16 v[28:29], v6 offset:8192
    ds_read_b64_tr_b16 v[30:31], v6 offset:9216
    s_waitcnt lgkmcnt(13)
    v_mfma_f32_32x32x16_bf16 v[192:207], v[36:39], v[16:19], v[192:207]
    ds_read_b128 v[16:19], v4
    ds_read_b64_tr_b16 v[32:33], v7 offset:8192
    s_waitcnt lgkmcnt(14)
    ds_read_b64_tr_b16 v[34:35], v7 offset:9216
    s_waitcnt lgkmcnt(11)
    v_mfma_f32_32x32x16_bf16 v[144:159], v[40:43], v[20:23], v[144:159]
    ds_read_b64_tr_b16 v[36:37], v8 offset:8192
    ds_read_b64_tr_b16 v[38:39], v8 offset:9216
    v_xor_b32 v4, 0x20, v4
    v_mfma_f32_32x32x16_bf16 v[160:175], v[44:47], v[20:23], v[160:175]
    ds_read_b64_tr_b16 v[40:41], v5 offset:12288
    ds_read_b64_tr_b16 v[42:43], v5 offset:13312
    s_waitcnt lgkmcnt(13)
    v_mfma_f32_32x32x16_bf16 v[176:191], v[48:51], v[20:23], v[176:191]
    ds_read_b64_tr_b16 v[44:45], v6 offset:12288
    ds_read_b64_tr_b16 v[46:47], v6 offset:13312
    v_xor_b32 v5, 0x10000, v5
    s_waitcnt lgkmcnt(13)
    v_mfma_f32_32x32x16_bf16 v[192:207], v[52:55], v[20:23], v[192:207]
    ds_read_b128 v[20:23], v4
    ds_read_b64_tr_b16 v[48:49], v7 offset:12288
    s_waitcnt lgkmcnt(14)
    ds_read_b64_tr_b16 v[50:51], v7 offset:13312
    v_xor_b32 v6, 0x10000, v6
    s_waitcnt lgkmcnt(11)
    v_mfma_f32_32x32x16_bf16 v[144:159], v[24:27], v[16:19], v[144:159]
    ds_read_b64_tr_b16 v[52:53], v8 offset:12288
    ds_read_b64_tr_b16 v[54:55], v8 offset:13312
    v_xor_b32 v4, 0x18060, v4
    v_xor_b32 v7, 0x10000, v7
    v_mfma_f32_32x32x16_bf16 v[160:175], v[28:31], v[16:19], v[160:175]
    ds_read_b64_tr_b16 v[24:25], v5 offset:32768
    ds_read_b64_tr_b16 v[26:27], v5 offset:33792
    v_xor_b32 v8, 0x10000, v8
    s_waitcnt lgkmcnt(13)
    v_mfma_f32_32x32x16_bf16 v[176:191], v[32:35], v[16:19], v[176:191]
    ds_read_b64_tr_b16 v[28:29], v6 offset:32768
    ds_read_b64_tr_b16 v[30:31], v6 offset:33792
    s_waitcnt lgkmcnt(13)
    v_mfma_f32_32x32x16_bf16 v[192:207], v[36:39], v[16:19], v[192:207]
    ds_read_b128 v[16:19], v4
    ds_read_b64_tr_b16 v[32:33], v7 offset:32768
    s_waitcnt lgkmcnt(14)
    ds_read_b64_tr_b16 v[34:35], v7 offset:33792
    s_waitcnt lgkmcnt(11)
    v_mfma_f32_32x32x16_bf16 v[144:159], v[40:43], v[20:23], v[144:159]
    ds_read_b64_tr_b16 v[36:37], v8 offset:32768
    ds_read_b64_tr_b16 v[38:39], v8 offset:33792
    v_xor_b32 v4, 0x20, v4
    v_mfma_f32_32x32x16_bf16 v[160:175], v[44:47], v[20:23], v[160:175]
    ds_read_b64_tr_b16 v[40:41], v5 offset:36864
    ds_read_b64_tr_b16 v[42:43], v5 offset:37888
    s_waitcnt lgkmcnt(13)
    v_mfma_f32_32x32x16_bf16 v[176:191], v[48:51], v[20:23], v[176:191]
    ds_read_b64_tr_b16 v[44:45], v6 offset:36864
    ds_read_b64_tr_b16 v[46:47], v6 offset:37888
    s_waitcnt lgkmcnt(13)
    v_mfma_f32_32x32x16_bf16 v[192:207], v[52:55], v[20:23], v[192:207]
    s_barrier
    ds_read_b128 v[20:23], v4
    ds_read_b64_tr_b16 v[48:49], v7 offset:36864
    s_waitcnt lgkmcnt(14)
    ds_read_b64_tr_b16 v[50:51], v7 offset:37888
    s_add_u32 s49, s49, 1
    s_cmp_lt_u32 s49, 3
    s_cbranch_scc1 g1_28
    v_xor_b32 v4, 0x60, v4
    s_waitcnt lgkmcnt(14)
    ds_read_b128 v[56:59], v4
    s_waitcnt lgkmcnt(14)
    ds_read_b64_tr_b16 v[32:33], v5 offset:40960
    s_waitcnt lgkmcnt(14)
    ds_read_b64_tr_b16 v[34:35], v5 offset:41984
    s_waitcnt lgkmcnt(14)
    ds_read_b64_tr_b16 v[36:37], v6 offset:40960
    s_waitcnt lgkmcnt(14)
    ds_read_b64_tr_b16 v[38:39], v6 offset:41984
    v_xor_b32 v4, 0x20, v4
    s_waitcnt lgkmcnt(14)
    v_mfma_f32_32x32x16_bf16 v[144:159], v[24:27], v[16:19], v[144:159]
    ds_read_b128 v[60:63], v4
    s_waitcnt lgkmcnt(14)
    ds_read_b64_tr_b16 v[48:49], v5 offset:45056
    s_waitcnt lgkmcnt(14)
    ds_read_b64_tr_b16 v[50:51], v5 offset:46080
    v_mfma_f32_32x32x16_bf16 v[160:175], v[28:31], v[16:19], v[160:175]
    s_waitcnt lgkmcnt(14)
    ds_read_b64_tr_b16 v[52:53], v6 offset:45056
    s_waitcnt lgkmcnt(14)
    ds_read_b64_tr_b16 v[54:55], v6 offset:46080
    v_xor_b32 v4, 0x8060, v4
    s_waitcnt lgkmcnt(12)
    v_mfma_f32_32x32x16_bf16 v[144:159], v[40:43], v[20:23], v[144:159]
    ds_read_b128 v[16:19], v4
    ds_read_b64_tr_b16 v[24:25], v5 offset:0
    ds_read_b64_tr_b16 v[26:27], v5 offset:1024
    v_mfma_f32_32x32x16_bf16 v[160:175], v[44:47], v[20:23], v[160:175]
    s_waitcnt lgkmcnt(14)
    ds_read_b64_tr_b16 v[28:29], v6 offset:0
    s_waitcnt lgkmcnt(14)
    ds_read_b64_tr_b16 v[30:31], v6 offset:1024
    v_xor_b32 v4, 0x20, v4
    s_waitcnt lgkmcnt(12)
    v_mfma_f32_32x32x16_bf16 v[144:159], v[32:35], v[56:59], v[144:159]
    ds_read_b128 v[20:23], v4
    ds_read_b64_tr_b16 v[40:41], v5 offset:4096
    ds_read_b64_tr_b16 v[42:43], v5 offset:5120
    s_waitcnt lgkmcnt(13)
    v_mfma_f32_32x32x16_bf16 v[160:175], v[36:39], v[56:59], v[160:175]
    ds_read_b64_tr_b16 v[44:45], v6 offset:4096
    ds_read_b64_tr_b16 v[46:47], v6 offset:5120
    v_xor_b32 v4, 0x60, v4
    s_waitcnt lgkmcnt(12)
    v_mfma_f32_32x32x16_bf16 v[144:159], v[48:51], v[60:63], v[144:159]
    ds_read_b128 v[56:59], v4
    ds_read_b64_tr_b16 v[32:33], v5 offset:8192
    ds_read_b64_tr_b16 v[34:35], v5 offset:9216
    s_waitcnt lgkmcnt(13)
    v_mfma_f32_32x32x16_bf16 v[160:175], v[52:55], v[60:63], v[160:175]
    ds_read_b64_tr_b16 v[36:37], v6 offset:8192
    ds_read_b64_tr_b16 v[38:39], v6 offset:9216
    v_xor_b32 v4, 0x20, v4
    s_waitcnt lgkmcnt(12)
    v_mfma_f32_32x32x16_bf16 v[144:159], v[24:27], v[16:19], v[144:159]
    ds_read_b128 v[60:63], v4
    ds_read_b64_tr_b16 v[48:49], v5 offset:12288
    ds_read_b64_tr_b16 v[50:51], v5 offset:13312
    v_xor_b32 v5, 0x10000, v5
    s_waitcnt lgkmcnt(13)
    v_mfma_f32_32x32x16_bf16 v[160:175], v[28:31], v[16:19], v[160:175]
    ds_read_b64_tr_b16 v[52:53], v6 offset:12288
    ds_read_b64_tr_b16 v[54:55], v6 offset:13312
    v_xor_b32 v4, 0x18060, v4
    v_xor_b32 v6, 0x10000, v6
    s_waitcnt lgkmcnt(12)
    v_mfma_f32_32x32x16_bf16 v[144:159], v[40:43], v[20:23], v[144:159]
    s_barrier
    ds_read_b128 v[16:19], v4
    ds_read_b64_tr_b16 v[24:25], v5 offset:32768
    ds_read_b64_tr_b16 v[26:27], v5 offset:33792
    s_waitcnt lgkmcnt(13)
    v_mfma_f32_32x32x16_bf16 v[160:175], v[44:47], v[20:23], v[160:175]
    ds_read_b64_tr_b16 v[28:29], v6 offset:32768
    ds_read_b64_tr_b16 v[30:31], v6 offset:33792
    v_xor_b32 v4, 0x20, v4
    s_waitcnt lgkmcnt(12)
    v_mfma_f32_32x32x16_bf16 v[144:159], v[32:35], v[56:59], v[144:159]
    ds_read_b128 v[20:23], v4
    ds_read_b64_tr_b16 v[40:41], v5 offset:36864
    ds_read_b64_tr_b16 v[42:43], v5 offset:37888
    s_waitcnt lgkmcnt(13)
    v_mfma_f32_32x32x16_bf16 v[160:175], v[36:39], v[56:59], v[160:175]
    ds_read_b64_tr_b16 v[44:45], v6 offset:36864
    ds_read_b64_tr_b16 v[46:47], v6 offset:37888
    v_xor_b32 v4, 0x60, v4
    s_waitcnt lgkmcnt(12)
    v_mfma_f32_32x32x16_bf16 v[144:159], v[48:51], v[60:63], v[144:159]
    ds_read_b128 v[56:59], v4
    ds_read_b64_tr_b16 v[32:33], v5 offset:40960
    ds_read_b64_tr_b16 v[34:35], v5 offset:41984
    s_waitcnt lgkmcnt(13)
    v_mfma_f32_32x32x16_bf16 v[160:175], v[52:55], v[60:63], v[160:175]
    ds_read_b64_tr_b16 v[36:37], v6 offset:40960
    ds_read_b64_tr_b16 v[38:39], v6 offset:41984
    v_xor_b32 v4, 0x20, v4
    s_waitcnt lgkmcnt(12)
    v_mfma_f32_32x32x16_bf16 v[144:159], v[24:27], v[16:19], v[144:159]
    ds_read_b128 v[60:63], v4
    ds_read_b64_tr_b16 v[48:49], v5 offset:45056
    ds_read_b64_tr_b16 v[50:51], v5 offset:46080
    s_waitcnt lgkmcnt(13)
    v_mfma_f32_32x32x16_bf16 v[160:175], v[28:31], v[16:19], v[160:175]
    ds_read_b64_tr_b16 v[52:53], v6 offset:45056
    ds_read_b64_tr_b16 v[54:55], v6 offset:46080
    v_xor_b32 v4, 0x8060, v4
    s_waitcnt lgkmcnt(12)
    v_mfma_f32_32x32x16_bf16 v[144:159], v[40:43], v[20:23], v[144:159]
    s_barrier
    ds_read_b128 v[16:19], v4
    ds_read_b64_tr_b16 v[24:25], v5 offset:0
    ds_read_b64_tr_b16 v[26:27], v5 offset:1024
    s_waitcnt lgkmcnt(13)
    v_mfma_f32_32x32x16_bf16 v[160:175], v[44:47], v[20:23], v[160:175]
    ds_read_b64_tr_b16 v[28:29], v6 offset:0
    ds_read_b64_tr_b16 v[30:31], v6 offset:1024
    v_xor_b32 v4, 0x20, v4
    s_waitcnt lgkmcnt(12)
    v_mfma_f32_32x32x16_bf16 v[144:159], v[32:35], v[56:59], v[144:159]
    ds_read_b128 v[20:23], v4
    ds_read_b64_tr_b16 v[40:41], v5 offset:4096
    ds_read_b64_tr_b16 v[42:43], v5 offset:5120
    s_waitcnt lgkmcnt(14)
    ds_read_b128 v[224:227], v9 offset:0
    s_waitcnt lgkmcnt(14)
    ds_read_b128 v[228:231], v9 offset:512
    s_waitcnt lgkmcnt(14)
    ds_read_b128 v[232:235], v9 offset:1024
    s_waitcnt lgkmcnt(14)
    ds_read_b128 v[236:239], v9 offset:1536
    s_waitcnt lgkmcnt(14)
    v_mfma_f32_32x32x16_bf16 v[160:175], v[36:39], v[56:59], v[160:175]
    ds_read_b64_tr_b16 v[44:45], v6 offset:4096
    s_waitcnt lgkmcnt(14)
    ds_read_b64_tr_b16 v[46:47], v6 offset:5120
    v_xor_b32 v4, 0x60, v4
    s_waitcnt lgkmcnt(14)
    v_mfma_f32_32x32x16_bf16 v[144:159], v[48:51], v[60:63], v[144:159]
    ds_read_b128 v[56:59], v4
    s_waitcnt lgkmcnt(14)
    ds_read_b64_tr_b16 v[32:33], v5 offset:8192
    s_waitcnt lgkmcnt(14)
    ds_read_b64_tr_b16 v[34:35], v5 offset:9216
    s_waitcnt lgkmcnt(14)
    ds_read_b128 v[240:243], v10 offset:2048
    s_waitcnt lgkmcnt(14)
    ds_read_b128 v[244:247], v11 offset:4096
    v_mov_b32 v9, 137216
    s_waitcnt lgkmcnt(14)
    ds_read_b64 v[14:15], v9 offset:16
    s_waitcnt lgkmcnt(14)
    v_mfma_f32_32x32x16_bf16 v[160:175], v[52:55], v[60:63], v[160:175]
    ds_read_b64_tr_b16 v[36:37], v6 offset:8192
    s_waitcnt lgkmcnt(14)
    ds_read_b64_tr_b16 v[38:39], v6 offset:9216
    v_xor_b32 v4, 0x20, v4
    s_waitcnt lgkmcnt(14)
    v_mfma_f32_32x32x16_bf16 v[144:159], v[24:27], v[16:19], v[144:159]
    ds_read_b128 v[60:63], v4
    s_waitcnt lgkmcnt(14)
    ds_read_b64_tr_b16 v[48:49], v5 offset:12288
    s_waitcnt lgkmcnt(14)
    ds_read_b64_tr_b16 v[50:51], v5 offset:13312
    s_waitcnt lgkmcnt(14)
    v_mfma_f32_32x32x16_bf16 v[160:175], v[28:31], v[16:19], v[160:175]
    ds_read_b64_tr_b16 v[52:53], v6 offset:12288
    s_waitcnt lgkmcnt(14)
    ds_read_b64_tr_b16 v[54:55], v6 offset:13312
    v_xor_b32 v4, 0x18060, v4
    s_waitcnt lgkmcnt(14)
    v_mfma_f32_32x32x16_bf16 v[144:159], v[40:43], v[20:23], v[144:159]
    ds_read_b128 v[16:19], v4
    s_waitcnt lgkmcnt(14)
    ds_read_b64_tr_b16 v[24:25], v7 offset:32768
    s_waitcnt lgkmcnt(14)
    ds_read_b64_tr_b16 v[26:27], v7 offset:33792
    s_waitcnt lgkmcnt(14)
    v_mfma_f32_32x32x16_bf16 v[160:175], v[44:47], v[20:23], v[160:175]
    ds_read_b64_tr_b16 v[28:29], v8 offset:32768
    s_waitcnt lgkmcnt(14)
    ds_read_b64_tr_b16 v[30:31], v8 offset:33792
    v_xor_b32 v4, 0x20, v4
    s_waitcnt lgkmcnt(14)
    v_mfma_f32_32x32x16_bf16 v[144:159], v[32:35], v[56:59], v[144:159]
    ds_read_b128 v[20:23], v4
    s_waitcnt lgkmcnt(14)
    ds_read_b64_tr_b16 v[40:41], v7 offset:36864
    s_waitcnt lgkmcnt(14)
    ds_read_b64_tr_b16 v[42:43], v7 offset:37888
    s_waitcnt lgkmcnt(13)
    v_mfma_f32_32x32x16_bf16 v[160:175], v[36:39], v[56:59], v[160:175]
    ds_read_b64_tr_b16 v[44:45], v8 offset:36864
    ds_read_b64_tr_b16 v[46:47], v8 offset:37888
    v_xor_b32 v4, 0x60, v4
    s_waitcnt lgkmcnt(12)
    v_mfma_f32_32x32x16_bf16 v[144:159], v[48:51], v[60:63], v[144:159]
    ds_read_b128 v[56:59], v4
    ds_read_b64_tr_b16 v[32:33], v7 offset:40960
    ds_read_b64_tr_b16 v[34:35], v7 offset:41984
    s_waitcnt lgkmcnt(13)
    v_mfma_f32_32x32x16_bf16 v[160:175], v[52:55], v[60:63], v[160:175]
    ds_read_b64_tr_b16 v[36:37], v8 offset:40960
    ds_read_b64_tr_b16 v[38:39], v8 offset:41984
    v_xor_b32 v4, 0x20, v4
    v_mfma_f32_32x32x16_bf16 v[144:159], v[224:227], v[240:243], v[144:159]
    v_mfma_f32_32x32x16_bf16 v[160:175], v[228:231], v[240:243], v[160:175]
    s_setprio 3
    v_readfirstlane_b32 s6, v14
    v_readfirstlane_b32 s7, v15
    s_lshl_b32 s55, s46, 8
    s_add_u32 s55, s55, s53
    v_mov_b32 v248, v245
    v_mov_b32 v249, v245
    v_mov_b32 v245, v244
    v_mov_b32 v247, v246
    s_nop 1
    v_pk_mul_f32 v[208:209], v[144:145], v[144:145]
    v_pk_mul_f32 v[210:211], v[146:147], v[146:147]
    v_pk_mul_f32 v[212:213], v[148:149], v[148:149]
    v_pk_mul_f32 v[214:215], v[150:151], v[150:151]
    v_pk_mul_f32 v[216:217], v[152:153], v[152:153]
    v_pk_mul_f32 v[218:219], v[154:155], v[154:155]
    v_pk_mul_f32 v[220:221], v[156:157], v[156:157]
    v_pk_mul_f32 v[222:223], v[158:159], v[158:159]
    v_pk_fma_f32 v[208:209], v[208:209], v[248:249], v[244:245]
    v_pk_fma_f32 v[210:211], v[210:211], v[248:249], v[244:245]
    v_pk_fma_f32 v[212:213], v[212:213], v[248:249], v[244:245]
    v_pk_fma_f32 v[214:215], v[214:215], v[248:249], v[244:245]
    v_pk_fma_f32 v[216:217], v[216:217], v[248:249], v[244:245]
    v_pk_fma_f32 v[218:219], v[218:219], v[248:249], v[244:245]
    v_pk_fma_f32 v[220:221], v[220:221], v[248:249], v[244:245]
    v_pk_fma_f32 v[222:223], v[222:223], v[248:249], v[244:245]
    v_pk_mul_f32 v[208:209], v[208:209], v[144:145]
    v_pk_mul_f32 v[210:211], v[210:211], v[146:147]
    v_pk_mul_f32 v[212:213], v[212:213], v[148:149]
    v_pk_mul_f32 v[214:215], v[214:215], v[150:151]
    v_pk_mul_f32 v[216:217], v[216:217], v[152:153]
    v_pk_mul_f32 v[218:219], v[218:219], v[154:155]
    v_pk_mul_f32 v[220:221], v[220:221], v[156:157]
    v_pk_mul_f32 v[222:223], v[222:223], v[158:159]
    v_exp_f32 v208, v208
    v_exp_f32 v209, v209
    v_exp_f32 v210, v210
    v_exp_f32 v211, v211
    v_exp_f32 v212, v212
    v_exp_f32 v213, v213
    v_exp_f32 v214, v214
    v_exp_f32 v215, v215
    v_exp_f32 v216, v216
    v_exp_f32 v217, v217
    v_exp_f32 v218, v218
    v_exp_f32 v219, v219
    v_exp_f32 v220, v220
    v_exp_f32 v221, v221
    v_exp_f32 v222, v222
    v_exp_f32 v223, v223
    v_pk_fma_f32 v[208:209], v[208:209], v[246:247], v[246:247]
    v_pk_fma_f32 v[210:211], v[210:211], v[246:247], v[246:247]
    v_pk_fma_f32 v[212:213], v[212:213], v[246:247], v[246:247]
    v_pk_fma_f32 v[214:215], v[214:215], v[246:247], v[246:247]
    v_pk_fma_f32 v[216:217], v[216:217], v[246:247], v[246:247]
    v_pk_fma_f32 v[218:219], v[218:219], v[246:247], v[246:247]
    v_pk_fma_f32 v[220:221], v[220:221], v[246:247], v[246:247]
    v_pk_fma_f32 v[222:223], v[222:223], v[246:247], v[246:247]
    v_rcp_f32 v208, v208
    v_rcp_f32 v209, v209
    v_rcp_f32 v210, v210
    v_rcp_f32 v211, v211
    v_rcp_f32 v212, v212
    v_rcp_f32 v213, v213
    v_rcp_f32 v214, v214
    v_rcp_f32 v215, v215
    v_rcp_f32 v216, v216
    v_rcp_f32 v217, v217
    v_rcp_f32 v218, v218
    v_rcp_f32 v219, v219
    v_rcp_f32 v220, v220
    v_rcp_f32 v221, v221
    v_rcp_f32 v222, v222
    v_rcp_f32 v223, v223
    v_pk_mul_f32 v[208:209], v[208:209], v[144:145]
    v_pk_mul_f32 v[210:211], v[210:211], v[146:147]
    v_pk_mul_f32 v[212:213], v[212:213], v[148:149]
    v_pk_mul_f32 v[214:215], v[214:215], v[150:151]
    v_pk_mul_f32 v[216:217], v[216:217], v[152:153]
    v_pk_mul_f32 v[218:219], v[218:219], v[154:155]
    v_pk_mul_f32 v[220:221], v[220:221], v[156:157]
    v_pk_mul_f32 v[222:223], v[222:223], v[158:159]
    v_cvt_pk_bf16_f32 v112, v208, v209
    v_cvt_pk_bf16_f32 v113, v210, v211
    v_cvt_pk_bf16_f32 v114, v212, v213
    v_cvt_pk_bf16_f32 v115, v214, v215
    v_cvt_pk_bf16_f32 v116, v216, v217
    v_cvt_pk_bf16_f32 v117, v218, v219
    v_cvt_pk_bf16_f32 v118, v220, v221
    v_cvt_pk_bf16_f32 v119, v222, v223
    buffer_store_dwordx4 v[112:115], v12, s[12:15], s51 offen offset:0 sc1
    buffer_store_dwordx4 v[116:119], v12, s[12:15], s51 offen offset:1024 sc1
    v_pk_mul_f32 v[208:209], v[160:161], v[160:161]
    v_pk_mul_f32 v[210:211], v[162:163], v[162:163]
    v_pk_mul_f32 v[212:213], v[164:165], v[164:165]
    v_pk_mul_f32 v[214:215], v[166:167], v[166:167]
    v_pk_mul_f32 v[216:217], v[168:169], v[168:169]
    v_pk_mul_f32 v[218:219], v[170:171], v[170:171]
    v_pk_mul_f32 v[220:221], v[172:173], v[172:173]
    v_pk_mul_f32 v[222:223], v[174:175], v[174:175]
    v_pk_fma_f32 v[208:209], v[208:209], v[248:249], v[244:245]
    v_pk_fma_f32 v[210:211], v[210:211], v[248:249], v[244:245]
    v_pk_fma_f32 v[212:213], v[212:213], v[248:249], v[244:245]
    v_pk_fma_f32 v[214:215], v[214:215], v[248:249], v[244:245]
    v_pk_fma_f32 v[216:217], v[216:217], v[248:249], v[244:245]
    v_pk_fma_f32 v[218:219], v[218:219], v[248:249], v[244:245]
    v_pk_fma_f32 v[220:221], v[220:221], v[248:249], v[244:245]
    v_pk_fma_f32 v[222:223], v[222:223], v[248:249], v[244:245]
    v_pk_mul_f32 v[208:209], v[208:209], v[160:161]
    v_pk_mul_f32 v[210:211], v[210:211], v[162:163]
    v_pk_mul_f32 v[212:213], v[212:213], v[164:165]
    v_pk_mul_f32 v[214:215], v[214:215], v[166:167]
    v_pk_mul_f32 v[216:217], v[216:217], v[168:169]
    v_pk_mul_f32 v[218:219], v[218:219], v[170:171]
    v_pk_mul_f32 v[220:221], v[220:221], v[172:173]
    v_pk_mul_f32 v[222:223], v[222:223], v[174:175]
    v_exp_f32 v208, v208
    v_exp_f32 v209, v209
    v_exp_f32 v210, v210
    v_exp_f32 v211, v211
    v_exp_f32 v212, v212
    v_exp_f32 v213, v213
    v_exp_f32 v214, v214
    v_exp_f32 v215, v215
    v_exp_f32 v216, v216
    v_exp_f32 v217, v217
    v_exp_f32 v218, v218
    v_exp_f32 v219, v219
    v_exp_f32 v220, v220
    v_exp_f32 v221, v221
    v_exp_f32 v222, v222
    v_exp_f32 v223, v223
    v_pk_fma_f32 v[208:209], v[208:209], v[246:247], v[246:247]
    v_pk_fma_f32 v[210:211], v[210:211], v[246:247], v[246:247]
    v_pk_fma_f32 v[212:213], v[212:213], v[246:247], v[246:247]
    v_pk_fma_f32 v[214:215], v[214:215], v[246:247], v[246:247]
    v_pk_fma_f32 v[216:217], v[216:217], v[246:247], v[246:247]
    v_pk_fma_f32 v[218:219], v[218:219], v[246:247], v[246:247]
    v_pk_fma_f32 v[220:221], v[220:221], v[246:247], v[246:247]
    v_pk_fma_f32 v[222:223], v[222:223], v[246:247], v[246:247]
    v_rcp_f32 v208, v208
    v_rcp_f32 v209, v209
    v_rcp_f32 v210, v210
    v_rcp_f32 v211, v211
    v_rcp_f32 v212, v212
    v_rcp_f32 v213, v213
    v_rcp_f32 v214, v214
    v_rcp_f32 v215, v215
    v_rcp_f32 v216, v216
    v_rcp_f32 v217, v217
    v_rcp_f32 v218, v218
    v_rcp_f32 v219, v219
    v_rcp_f32 v220, v220
    v_rcp_f32 v221, v221
    v_rcp_f32 v222, v222
    v_rcp_f32 v223, v223
    v_pk_mul_f32 v[208:209], v[208:209], v[160:161]
    v_pk_mul_f32 v[210:211], v[210:211], v[162:163]
    v_pk_mul_f32 v[212:213], v[212:213], v[164:165]
    v_pk_mul_f32 v[214:215], v[214:215], v[166:167]
    v_pk_mul_f32 v[216:217], v[216:217], v[168:169]
    v_pk_mul_f32 v[218:219], v[218:219], v[170:171]
    v_pk_mul_f32 v[220:221], v[220:221], v[172:173]
    v_pk_mul_f32 v[222:223], v[222:223], v[174:175]
    v_cvt_pk_bf16_f32 v120, v208, v209
    v_cvt_pk_bf16_f32 v121, v210, v211
    v_cvt_pk_bf16_f32 v122, v212, v213
    v_cvt_pk_bf16_f32 v123, v214, v215
    v_cvt_pk_bf16_f32 v124, v216, v217
    v_cvt_pk_bf16_f32 v125, v218, v219
    v_cvt_pk_bf16_f32 v126, v220, v221
    v_cvt_pk_bf16_f32 v127, v222, v223
    buffer_store_dwordx4 v[120:123], v12, s[12:15], s51 offen offset:2048 sc1
    buffer_store_dwordx4 v[124:127], v12, s[12:15], s51 offen offset:3072 sc1
    s_add_u32 s51, s51, 4096
    s_waitcnt lgkmcnt(12)
    v_mfma_f32_32x32x16_bf16 v[176:191], v[24:27], v[16:19], v[176:191]
    ds_read_b128 v[60:63], v4
    ds_read_b64_tr_b16 v[48:49], v7 offset:45056
    ds_read_b64_tr_b16 v[50:51], v7 offset:46080
    s_waitcnt lgkmcnt(13)
    v_mfma_f32_32x32x16_bf16 v[192:207], v[28:31], v[16:19], v[192:207]
    ds_read_b64_tr_b16 v[52:53], v8 offset:45056
    ds_read_b64_tr_b16 v[54:55], v8 offset:46080
    v_xor_b32 v4, 0x8060, v4
    s_waitcnt lgkmcnt(12)
    v_mfma_f32_32x32x16_bf16 v[176:191], v[40:43], v[20:23], v[176:191]
    ds_read_b128 v[16:19], v4
    ds_read_b64_tr_b16 v[24:25], v7 offset:0
    ds_read_b64_tr_b16 v[26:27], v7 offset:1024
    s_waitcnt lgkmcnt(13)
    v_mfma_f32_32x32x16_bf16 v[192:207], v[44:47], v[20:23], v[192:207]
    ds_read_b64_tr_b16 v[28:29], v8 offset:0
    ds_read_b64_tr_b16 v[30:31], v8 offset:1024
    v_xor_b32 v4, 0x20, v4
    s_waitcnt lgkmcnt(12)
    v_mfma_f32_32x32x16_bf16 v[176:191], v[32:35], v[56:59], v[176:191]
    ds_read_b128 v[20:23], v4
    ds_read_b64_tr_b16 v[40:41], v7 offset:4096
    ds_read_b64_tr_b16 v[42:43], v7 offset:5120
    s_waitcnt lgkmcnt(13)
    v_mfma_f32_32x32x16_bf16 v[192:207], v[36:39], v[56:59], v[192:207]
    ds_read_b64_tr_b16 v[44:45], v8 offset:4096
    ds_read_b64_tr_b16 v[46:47], v8 offset:5120
    v_xor_b32 v4, 0x60, v4
    s_waitcnt lgkmcnt(12)
    v_mfma_f32_32x32x16_bf16 v[176:191], v[48:51], v[60:63], v[176:191]
    ds_read_b128 v[56:59], v4
    ds_read_b64_tr_b16 v[32:33], v7 offset:8192
    ds_read_b64_tr_b16 v[34:35], v7 offset:9216
    s_waitcnt lgkmcnt(13)
    v_mfma_f32_32x32x16_bf16 v[192:207], v[52:55], v[60:63], v[192:207]
    ds_read_b64_tr_b16 v[36:37], v8 offset:8192
    ds_read_b64_tr_b16 v[38:39], v8 offset:9216
    v_xor_b32 v4, 0x20, v4
    s_waitcnt lgkmcnt(12)
    v_mfma_f32_32x32x16_bf16 v[176:191], v[24:27], v[16:19], v[176:191]
    ds_read_b128 v[60:63], v4
    ds_read_b64_tr_b16 v[48:49], v7 offset:12288
    ds_read_b64_tr_b16 v[50:51], v7 offset:13312
    v_xor_b32 v7, 0x10000, v7
    s_waitcnt lgkmcnt(13)
    v_mfma_f32_32x32x16_bf16 v[192:207], v[28:31], v[16:19], v[192:207]
    ds_read_b64_tr_b16 v[52:53], v8 offset:12288
    ds_read_b64_tr_b16 v[54:55], v8 offset:13312
    v_xor_b32 v4, 0x18060, v4
    v_xor_b32 v8, 0x10000, v8
    s_waitcnt lgkmcnt(12)
    v_mfma_f32_32x32x16_bf16 v[176:191], v[40:43], v[20:23], v[176:191]
    ds_read_b128 v[16:19], v4
    ds_read_b64_tr_b16 v[24:25], v7 offset:32768
    ds_read_b64_tr_b16 v[26:27], v7 offset:33792
    s_waitcnt lgkmcnt(13)
    v_mfma_f32_32x32x16_bf16 v[192:207], v[44:47], v[20:23], v[192:207]
    ds_read_b64_tr_b16 v[28:29], v8 offset:32768
    ds_read_b64_tr_b16 v[30:31], v8 offset:33792
    v_xor_b32 v4, 0x20, v4
    s_waitcnt lgkmcnt(12)
    v_mfma_f32_32x32x16_bf16 v[176:191], v[32:35], v[56:59], v[176:191]
    ds_read_b128 v[20:23], v4
    ds_read_b64_tr_b16 v[40:41], v7 offset:36864
    ds_read_b64_tr_b16 v[42:43], v7 offset:37888
    s_waitcnt lgkmcnt(13)
    v_mfma_f32_32x32x16_bf16 v[192:207], v[36:39], v[56:59], v[192:207]
    ds_read_b64_tr_b16 v[44:45], v8 offset:36864
    ds_read_b64_tr_b16 v[46:47], v8 offset:37888
    v_xor_b32 v4, 0x60, v4
    s_waitcnt lgkmcnt(12)
    v_mfma_f32_32x32x16_bf16 v[176:191], v[48:51], v[60:63], v[176:191]
    ds_read_b128 v[56:59], v4
    ds_read_b64_tr_b16 v[32:33], v7 offset:40960
    ds_read_b64_tr_b16 v[34:35], v7 offset:41984
    s_waitcnt lgkmcnt(13)
    v_mfma_f32_32x32x16_bf16 v[192:207], v[52:55], v[60:63], v[192:207]
    s_barrier
    ds_read_b64_tr_b16 v[36:37], v8 offset:40960
    ds_read_b64_tr_b16 v[38:39], v8 offset:41984
    v_xor_b32 v4, 0x20, v4
    s_waitcnt lgkmcnt(12)
    v_mfma_f32_32x32x16_bf16 v[176:191], v[24:27], v[16:19], v[176:191]
    ds_read_b128 v[60:63], v4
    ds_read_b64_tr_b16 v[48:49], v7 offset:45056
    ds_read_b64_tr_b16 v[50:51], v7 offset:46080
    s_waitcnt lgkmcnt(13)
    v_mfma_f32_32x32x16_bf16 v[192:207], v[28:31], v[16:19], v[192:207]
    ds_read_b64_tr_b16 v[52:53], v8 offset:45056
    ds_read_b64_tr_b16 v[54:55], v8 offset:46080
    v_xor_b32 v4, 0x8060, v4
    s_waitcnt vmcnt(0)
    v_mov_b32 v10, s6
    v_mov_b32 v11, s7
    v_lshlrev_b32 v3, 3, v1
    s_mov_b64 exec, 0xffff
    buffer_store_dwordx2 v[10:11], v3, s[12:15], s55 offen sc1
    s_mov_b64 exec, -1
    v_lshrrev_b32 v3, 5, v1
    s_waitcnt lgkmcnt(12)
    v_mfma_f32_32x32x16_bf16 v[176:191], v[40:43], v[20:23], v[176:191]
    ds_read_b128 v[16:19], v4
    ds_read_b64_tr_b16 v[24:25], v7 offset:0
    ds_read_b64_tr_b16 v[26:27], v7 offset:1024
    s_waitcnt lgkmcnt(13)
    v_mfma_f32_32x32x16_bf16 v[192:207], v[44:47], v[20:23], v[192:207]
    ds_read_b64_tr_b16 v[28:29], v8 offset:0
    ds_read_b64_tr_b16 v[30:31], v8 offset:1024
    v_xor_b32 v4, 0x20, v4
    s_waitcnt lgkmcnt(12)
    v_mfma_f32_32x32x16_bf16 v[176:191], v[32:35], v[56:59], v[176:191]
    ds_read_b128 v[20:23], v4
    ds_read_b64_tr_b16 v[40:41], v7 offset:4096
    ds_read_b64_tr_b16 v[42:43], v7 offset:5120
    s_waitcnt lgkmcnt(13)
    v_mfma_f32_32x32x16_bf16 v[192:207], v[36:39], v[56:59], v[192:207]
    ds_read_b64_tr_b16 v[44:45], v8 offset:4096
    ds_read_b64_tr_b16 v[46:47], v8 offset:5120
    v_xor_b32 v4, 0x60, v4
    s_waitcnt lgkmcnt(12)
    v_mfma_f32_32x32x16_bf16 v[176:191], v[48:51], v[60:63], v[176:191]
    ds_read_b128 v[56:59], v4
    ds_read_b64_tr_b16 v[32:33], v7 offset:8192
    ds_read_b64_tr_b16 v[34:35], v7 offset:9216
    s_waitcnt lgkmcnt(13)
    v_mfma_f32_32x32x16_bf16 v[192:207], v[52:55], v[60:63], v[192:207]
    ds_read_b64_tr_b16 v[36:37], v8 offset:8192
    ds_read_b64_tr_b16 v[38:39], v8 offset:9216
    v_xor_b32 v4, 0x20, v4
    s_waitcnt lgkmcnt(12)
    v_mfma_f32_32x32x16_bf16 v[176:191], v[24:27], v[16:19], v[176:191]
    ds_read_b128 v[60:63], v4
    ds_read_b64_tr_b16 v[48:49], v7 offset:12288
    ds_read_b64_tr_b16 v[50:51], v7 offset:13312
    s_waitcnt lgkmcnt(13)
    v_mfma_f32_32x32x16_bf16 v[192:207], v[28:31], v[16:19], v[192:207]
    ds_read_b64_tr_b16 v[52:53], v8 offset:12288
    ds_read_b64_tr_b16 v[54:55], v8 offset:13312
    v_xor_b32 v4, 0x18060, v4
    s_waitcnt lgkmcnt(12)
    v_mfma_f32_32x32x16_bf16 v[176:191], v[40:43], v[20:23], v[176:191]
    s_waitcnt lgkmcnt(10)
    v_mfma_f32_32x32x16_bf16 v[192:207], v[44:47], v[20:23], v[192:207]
    s_waitcnt lgkmcnt(7)
    v_mfma_f32_32x32x16_bf16 v[176:191], v[32:35], v[56:59], v[176:191]
    s_waitcnt lgkmcnt(5)
    v_mfma_f32_32x32x16_bf16 v[192:207], v[36:39], v[56:59], v[192:207]
    s_waitcnt lgkmcnt(2)
    v_mfma_f32_32x32x16_bf16 v[176:191], v[48:51], v[60:63], v[176:191]
    s_waitcnt lgkmcnt(0)
    v_mfma_f32_32x32x16_bf16 v[192:207], v[52:55], v[60:63], v[192:207]
    s_barrier
    v_mfma_f32_32x32x16_bf16 v[176:191], v[232:235], v[240:243], v[176:191]
    v_mfma_f32_32x32x16_bf16 v[192:207], v[236:239], v[240:243], v[192:207]
    v_bfe_u32 v9, v1, 2, 2
    v_lshl_add_u32 v9, v3, 2, v9
    v_mul_u32_u24 v4, 320, v9
    v_bfe_u32 v9, v1, 4, 1
    v_lshl_add_u32 v4, v9, 5, v4
    v_and_b32 v9, 3, v1
    v_lshl_add_u32 v4, v9, 3, v4
    v_mov_b32 v9, v4
    v_mul_u32_u24 v7, 10240, v3
    v_add_u32 v7, v7, v13
    v_lshlrev_b32 v13, 8, v2
    s_add_u32 s56, s46, 1
    s_and_b32 s56, s56, 3
    s_mul_i32 s56, s56, 8192
    s_add_u32 s56, s56, s50
    s_add_u32 s59, s56, 4096
    s_add_u32 s57, s46, 2
    s_and_b32 s57, s57, 3
    s_mul_i32 s57, s57, 8192
    s_add_u32 s57, s57, s50
    s_add_u32 s60, s57, 4096
    s_add_u32 s58, s46, 3
    s_and_b32 s58, s58, 3
    s_mul_i32 s58, s58, 8192
    s_add_u32 s58, s58, s50
    s_add_u32 s61, s58, 4096
    v_pk_mul_f32 v[208:209], v[176:177], v[176:177]
    v_pk_mul_f32 v[210:211], v[178:179], v[178:179]
    v_pk_mul_f32 v[212:213], v[180:181], v[180:181]
    v_pk_mul_f32 v[214:215], v[182:183], v[182:183]
    v_pk_mul_f32 v[216:217], v[184:185], v[184:185]
    v_pk_mul_f32 v[218:219], v[186:187], v[186:187]
    v_pk_mul_f32 v[220:221], v[188:189], v[188:189]
    v_pk_mul_f32 v[222:223], v[190:191], v[190:191]
    v_pk_fma_f32 v[208:209], v[208:209], v[248:249], v[244:245]
    v_pk_fma_f32 v[210:211], v[210:211], v[248:249], v[244:245]
    v_pk_fma_f32 v[212:213], v[212:213], v[248:249], v[244:245]
    v_pk_fma_f32 v[214:215], v[214:215], v[248:249], v[244:245]
    v_pk_fma_f32 v[216:217], v[216:217], v[248:249], v[244:245]
    v_pk_fma_f32 v[218:219], v[218:219], v[248:249], v[244:245]
    v_pk_fma_f32 v[220:221], v[220:221], v[248:249], v[244:245]
    v_pk_fma_f32 v[222:223], v[222:223], v[248:249], v[244:245]
    v_pk_mul_f32 v[208:209], v[208:209], v[176:177]
    v_pk_mul_f32 v[210:211], v[210:211], v[178:179]
    v_pk_mul_f32 v[212:213], v[212:213], v[180:181]
    v_pk_mul_f32 v[214:215], v[214:215], v[182:183]
    v_pk_mul_f32 v[216:217], v[216:217], v[184:185]
    v_pk_mul_f32 v[218:219], v[218:219], v[186:187]
    v_pk_mul_f32 v[220:221], v[220:221], v[188:189]
    v_pk_mul_f32 v[222:223], v[222:223], v[190:191]
    v_exp_f32 v208, v208
    v_exp_f32 v209, v209
    v_exp_f32 v210, v210
    v_exp_f32 v211, v211
    v_exp_f32 v212, v212
    v_exp_f32 v213, v213
    v_exp_f32 v214, v214
    v_exp_f32 v215, v215
    v_exp_f32 v216, v216
    v_exp_f32 v217, v217
    v_exp_f32 v218, v218
    v_exp_f32 v219, v219
    v_exp_f32 v220, v220
    v_exp_f32 v221, v221
    v_exp_f32 v222, v222
    v_exp_f32 v223, v223
    v_pk_fma_f32 v[208:209], v[208:209], v[246:247], v[246:247]
    v_pk_fma_f32 v[210:211], v[210:211], v[246:247], v[246:247]
    v_pk_fma_f32 v[212:213], v[212:213], v[246:247], v[246:247]
    v_pk_fma_f32 v[214:215], v[214:215], v[246:247], v[246:247]
    v_pk_fma_f32 v[216:217], v[216:217], v[246:247], v[246:247]
    v_pk_fma_f32 v[218:219], v[218:219], v[246:247], v[246:247]
    v_pk_fma_f32 v[220:221], v[220:221], v[246:247], v[246:247]
    v_pk_fma_f32 v[222:223], v[222:223], v[246:247], v[246:247]
    v_rcp_f32 v208, v208
    v_rcp_f32 v209, v209
    v_rcp_f32 v210, v210
    v_rcp_f32 v211, v211
    v_rcp_f32 v212, v212
    v_rcp_f32 v213, v213
    v_rcp_f32 v214, v214
    v_rcp_f32 v215, v215
    v_rcp_f32 v216, v216
    v_rcp_f32 v217, v217
    v_rcp_f32 v218, v218
    v_rcp_f32 v219, v219
    v_rcp_f32 v220, v220
    v_rcp_f32 v221, v221
    v_rcp_f32 v222, v222
    v_rcp_f32 v223, v223
    v_pk_mul_f32 v[208:209], v[208:209], v[176:177]
    v_pk_mul_f32 v[210:211], v[210:211], v[178:179]
    v_pk_mul_f32 v[212:213], v[212:213], v[180:181]
    v_pk_mul_f32 v[214:215], v[214:215], v[182:183]
    v_pk_mul_f32 v[216:217], v[216:217], v[184:185]
    v_pk_mul_f32 v[218:219], v[218:219], v[186:187]
    v_pk_mul_f32 v[220:221], v[220:221], v[188:189]
    v_pk_mul_f32 v[222:223], v[222:223], v[190:191]
    v_cvt_pk_bf16_f32 v128, v208, v209
    v_cvt_pk_bf16_f32 v129, v210, v211
    v_cvt_pk_bf16_f32 v130, v212, v213
    v_cvt_pk_bf16_f32 v131, v214, v215
    v_cvt_pk_bf16_f32 v132, v216, v217
    v_cvt_pk_bf16_f32 v133, v218, v219
    v_cvt_pk_bf16_f32 v134, v220, v221
    v_cvt_pk_bf16_f32 v135, v222, v223
    buffer_store_dwordx4 v[128:131], v12, s[12:15], s51 offen offset:0 sc1
    buffer_store_dwordx4 v[132:135], v12, s[12:15], s51 offen offset:1024 sc1
    v_pk_mul_f32 v[208:209], v[192:193], v[192:193]
    v_pk_mul_f32 v[210:211], v[194:195], v[194:195]
    v_pk_mul_f32 v[212:213], v[196:197], v[196:197]
    v_pk_mul_f32 v[214:215], v[198:199], v[198:199]
    v_pk_mul_f32 v[216:217], v[200:201], v[200:201]
    v_pk_mul_f32 v[218:219], v[202:203], v[202:203]
    v_pk_mul_f32 v[220:221], v[204:205], v[204:205]
    v_pk_mul_f32 v[222:223], v[206:207], v[206:207]
    v_pk_fma_f32 v[208:209], v[208:209], v[248:249], v[244:245]
    v_pk_fma_f32 v[210:211], v[210:211], v[248:249], v[244:245]
    v_pk_fma_f32 v[212:213], v[212:213], v[248:249], v[244:245]
    v_pk_fma_f32 v[214:215], v[214:215], v[248:249], v[244:245]
    v_pk_fma_f32 v[216:217], v[216:217], v[248:249], v[244:245]
    v_pk_fma_f32 v[218:219], v[218:219], v[248:249], v[244:245]
    v_pk_fma_f32 v[220:221], v[220:221], v[248:249], v[244:245]
    v_pk_fma_f32 v[222:223], v[222:223], v[248:249], v[244:245]
    v_pk_mul_f32 v[208:209], v[208:209], v[192:193]
    v_pk_mul_f32 v[210:211], v[210:211], v[194:195]
    v_pk_mul_f32 v[212:213], v[212:213], v[196:197]
    v_pk_mul_f32 v[214:215], v[214:215], v[198:199]
    v_pk_mul_f32 v[216:217], v[216:217], v[200:201]
    v_pk_mul_f32 v[218:219], v[218:219], v[202:203]
    v_pk_mul_f32 v[220:221], v[220:221], v[204:205]
    v_pk_mul_f32 v[222:223], v[222:223], v[206:207]
    v_exp_f32 v208, v208
    v_exp_f32 v209, v209
    v_exp_f32 v210, v210
    v_exp_f32 v211, v211
    v_exp_f32 v212, v212
    v_exp_f32 v213, v213
    v_exp_f32 v214, v214
    v_exp_f32 v215, v215
    v_exp_f32 v216, v216
    v_exp_f32 v217, v217
    v_exp_f32 v218, v218
    v_exp_f32 v219, v219
    v_exp_f32 v220, v220
    v_exp_f32 v221, v221
    v_exp_f32 v222, v222
    v_exp_f32 v223, v223
    v_pk_fma_f32 v[208:209], v[208:209], v[246:247], v[246:247]
    v_pk_fma_f32 v[210:211], v[210:211], v[246:247], v[246:247]
    v_pk_fma_f32 v[212:213], v[212:213], v[246:247], v[246:247]
    v_pk_fma_f32 v[214:215], v[214:215], v[246:247], v[246:247]
    v_pk_fma_f32 v[216:217], v[216:217], v[246:247], v[246:247]
    v_pk_fma_f32 v[218:219], v[218:219], v[246:247], v[246:247]
    v_pk_fma_f32 v[220:221], v[220:221], v[246:247], v[246:247]
    v_pk_fma_f32 v[222:223], v[222:223], v[246:247], v[246:247]
    v_rcp_f32 v208, v208
    v_rcp_f32 v209, v209
    v_rcp_f32 v210, v210
    v_rcp_f32 v211, v211
    v_rcp_f32 v212, v212
    v_rcp_f32 v213, v213
    v_rcp_f32 v214, v214
    v_rcp_f32 v215, v215
    v_rcp_f32 v216, v216
    v_rcp_f32 v217, v217
    v_rcp_f32 v218, v218
    v_rcp_f32 v219, v219
    v_rcp_f32 v220, v220
    v_rcp_f32 v221, v221
    v_rcp_f32 v222, v222
    v_rcp_f32 v223, v223
    v_pk_mul_f32 v[208:209], v[208:209], v[192:193]
    v_pk_mul_f32 v[210:211], v[210:211], v[194:195]
    v_pk_mul_f32 v[212:213], v[212:213], v[196:197]
    v_pk_mul_f32 v[214:215], v[214:215], v[198:199]
    v_pk_mul_f32 v[216:217], v[216:217], v[200:201]
    v_pk_mul_f32 v[218:219], v[218:219], v[202:203]
    v_pk_mul_f32 v[220:221], v[220:221], v[204:205]
    v_pk_mul_f32 v[222:223], v[222:223], v[206:207]
    v_cvt_pk_bf16_f32 v136, v208, v209
    v_cvt_pk_bf16_f32 v137, v210, v211
    v_cvt_pk_bf16_f32 v138, v212, v213
    v_cvt_pk_bf16_f32 v139, v214, v215
    v_cvt_pk_bf16_f32 v140, v216, v217
    v_cvt_pk_bf16_f32 v141, v218, v219
    v_cvt_pk_bf16_f32 v142, v220, v221
    v_cvt_pk_bf16_f32 v143, v222, v223
    s_mov_b64 exec, 15
    buffer_load_dwordx2 v[14:15], v13, s[12:15], s53 offen sc1
    s_mov_b64 exec, -1
    buffer_store_dwordx4 v[136:139], v12, s[12:15], s51 offen offset:2048 sc1
    buffer_store_dwordx4 v[140:143], v12, s[12:15], s51 offen offset:3072 sc1
    s_barrier
    s_add_u32 s62, s43, 0
    s_and_b32 s62, s62, 7
    s_lshl_b32 s62, s62, 2
    s_lshr_b32 s62, 0x1234567, s62
    s_and_b32 s62, s62, 7
    s_mul_i32 s62, s62, 20480
    v_add_u32 v4, s62, v9
    ds_read_b64_tr_b16 v[224:225], v4 offset:0
    ds_read_b64_tr_b16 v[226:227], v4 offset:2560
    ds_read_b64_tr_b16 v[228:229], v4 offset:64
    ds_read_b64_tr_b16 v[230:231], v4 offset:2624
    ds_read_b64_tr_b16 v[232:233], v4 offset:128
    ds_read_b64_tr_b16 v[234:235], v4 offset:2688
    ds_read_b64_tr_b16 v[236:237], v4 offset:192
    ds_read_b64_tr_b16 v[238:239], v4 offset:2752
    ds_read_b64_tr_b16 v[240:241], v4 offset:256
    ds_read_b64_tr_b16 v[242:243], v4 offset:2816
    ds_read_b64_tr_b16 v[244:245], v4 offset:5120
    ds_read_b64_tr_b16 v[246:247], v4 offset:7680
    s_waitcnt lgkmcnt(10)
    v_mfma_f32_32x32x16_bf16 v[144:159], v[112:115], v[224:227], 0
    ds_read_b64_tr_b16 v[248:249], v4 offset:5184
    ds_read_b64_tr_b16 v[250:251], v4 offset:7744
    s_waitcnt lgkmcnt(10)
    v_mfma_f32_32x32x16_bf16 v[160:175], v[112:115], v[228:231], 0
    ds_read_b64_tr_b16 v[252:253], v4 offset:5248
    ds_read_b64_tr_b16 v[254:255], v4 offset:7808
    s_waitcnt lgkmcnt(10)
    v_mfma_f32_32x32x16_bf16 v[176:191], v[112:115], v[232:235], 0
    ds_read_b64_tr_b16 v[224:225], v4 offset:5312
    ds_read_b64_tr_b16 v[226:227], v4 offset:7872
    s_waitcnt lgkmcnt(10)
    v_mfma_f32_32x32x16_bf16 v[192:207], v[112:115], v[236:239], 0
    ds_read_b64_tr_b16 v[228:229], v4 offset:5376
    ds_read_b64_tr_b16 v[230:231], v4 offset:7936
    s_waitcnt lgkmcnt(10)
    v_mfma_f32_32x32x16_bf16 v[208:223], v[112:115], v[240:243], 0
    ds_read_b64_tr_b16 v[232:233], v4 offset:10240
    ds_read_b64_tr_b16 v[234:235], v4 offset:12800
    s_waitcnt lgkmcnt(10)
    v_mfma_f32_32x32x16_bf16 v[144:159], v[116:119], v[244:247], v[144:159]
    ds_read_b64_tr_b16 v[236:237], v4 offset:10304
    ds_read_b64_tr_b16 v[238:239], v4 offset:12864
    s_waitcnt lgkmcnt(10)
    v_mfma_f32_32x32x16_bf16 v[160:175], v[116:119], v[248:251], v[160:175]
    ds_read_b64_tr_b16 v[240:241], v4 offset:10368
    ds_read_b64_tr_b16 v[242:243], v4 offset:12928
    s_waitcnt lgkmcnt(10)
    v_mfma_f32_32x32x16_bf16 v[176:191], v[116:119], v[252:255], v[176:191]
    ds_read_b64_tr_b16 v[244:245], v4 offset:10432
    ds_read_b64_tr_b16 v[246:247], v4 offset:12992
    s_waitcnt lgkmcnt(10)
    v_mfma_f32_32x32x16_bf16 v[192:207], v[116:119], v[224:227], v[192:207]
    ds_read_b64_tr_b16 v[248:249], v4 offset:10496
    ds_read_b64_tr_b16 v[250:251], v4 offset:13056
    s_waitcnt lgkmcnt(10)
    v_mfma_f32_32x32x16_bf16 v[208:223], v[116:119], v[228:231], v[208:223]
    ds_read_b64_tr_b16 v[252:253], v4 offset:15360
    ds_read_b64_tr_b16 v[254:255], v4 offset:17920
    s_waitcnt vmcnt(2)
    s_mov_b64 exec, 15
    v_cmp_ne_u64 vcc, s[6:7], v[14:15]
    s_cbranch_vccz L_29
    s_mov_b32 s40, 0
poll_30:
    buffer_load_dwordx2 v[14:15], v13, s[12:15], s53 offen offset:0 sc1
pollc_32:
    s_waitcnt vmcnt(0)
    v_cmp_ne_u64 vcc, s[6:7], v[14:15]
    s_add_u32 s40, s40, 1
    s_cbranch_vccz pollx_31
    s_sleep 2
    s_cmp_lt_u32 s40, 400000
    s_cbranch_scc1 poll_30
pollx_31:
L_29:
    s_mov_b64 exec, -1
    s_waitcnt lgkmcnt(10)
    v_mfma_f32_32x32x16_bf16 v[144:159], v[120:123], v[232:235], v[144:159]
    ds_read_b64_tr_b16 v[224:225], v4 offset:15424
    ds_read_b64_tr_b16 v[226:227], v4 offset:17984
    buffer_load_dwordx4 v[64:67], v12, s[12:15], s56 offen offset:0 sc1
    s_waitcnt lgkmcnt(10)
    v_mfma_f32_32x32x16_bf16 v[160:175], v[120:123], v[236:239], v[160:175]
    ds_read_b64_tr_b16 v[228:229], v4 offset:15488
    ds_read_b64_tr_b16 v[230:231], v4 offset:18048
    buffer_load_dwordx4 v[68:71], v12, s[12:15], s56 offen offset:1024 sc1
    s_waitcnt lgkmcnt(10)
    v_mfma_f32_32x32x16_bf16 v[176:191], v[120:123], v[240:243], v[176:191]
    ds_read_b64_tr_b16 v[232:233], v4 offset:15552
    ds_read_b64_tr_b16 v[234:235], v4 offset:18112
    buffer_load_dwordx4 v[72:75], v12, s[12:15], s56 offen offset:2048 sc1
    s_waitcnt lgkmcnt(10)
    v_mfma_f32_32x32x16_bf16 v[192:207], v[120:123], v[244:247], v[192:207]
    ds_read_b64_tr_b16 v[236:237], v4 offset:15616
    ds_read_b64_tr_b16 v[238:239], v4 offset:18176
    buffer_load_dwordx4 v[76:79], v12, s[12:15], s56 offen offset:3072 sc1
    s_waitcnt lgkmcnt(10)
    v_mfma_f32_32x32x16_bf16 v[208:223], v[120:123], v[248:251], v[208:223]
    s_add_u32 s62, s43, 1
    s_and_b32 s62, s62, 7
    s_lshl_b32 s62, s62, 2
    s_lshr_b32 s62, 0x1234567, s62
    s_and_b32 s62, s62, 7
    s_mul_i32 s62, s62, 20480
    v_add_u32 v5, s62, v9
    ds_read_b64_tr_b16 v[240:241], v5 offset:0
    ds_read_b64_tr_b16 v[242:243], v5 offset:2560
    buffer_load_dwordx4 v[80:83], v12, s[12:15], s57 offen offset:0 sc1
    s_waitcnt lgkmcnt(10)
    v_mfma_f32_32x32x16_bf16 v[144:159], v[124:127], v[252:255], v[144:159]
    ds_read_b64_tr_b16 v[244:245], v5 offset:64
    ds_read_b64_tr_b16 v[246:247], v5 offset:2624
    buffer_load_dwordx4 v[84:87], v12, s[12:15], s57 offen offset:1024 sc1
    s_waitcnt lgkmcnt(10)
    v_mfma_f32_32x32x16_bf16 v[160:175], v[124:127], v[224:227], v[160:175]
    ds_read_b64_tr_b16 v[248:249], v5 offset:128
    ds_read_b64_tr_b16 v[250:251], v5 offset:2688
    buffer_load_dwordx4 v[88:91], v12, s[12:15], s57 offen offset:2048 sc1
    s_waitcnt lgkmcnt(10)
    v_mfma_f32_32x32x16_bf16 v[176:191], v[124:127], v[228:231], v[176:191]
    ds_read_b64_tr_b16 v[252:253], v5 offset:192
    ds_read_b64_tr_b16 v[254:255], v5 offset:2752
    buffer_load_dwordx4 v[92:95], v12, s[12:15], s57 offen offset:3072 sc1
    s_waitcnt lgkmcnt(10)
    v_mfma_f32_32x32x16_bf16 v[192:207], v[124:127], v[232:235], v[192:207]
    ds_read_b64_tr_b16 v[224:225], v5 offset:256
    ds_read_b64_tr_b16 v[226:227], v5 offset:2816
    buffer_load_dwordx4 v[96:99], v12, s[12:15], s58 offen offset:0 sc1
    s_waitcnt lgkmcnt(10)
    v_mfma_f32_32x32x16_bf16 v[208:223], v[124:127], v[236:239], v[208:223]
    ds_read_b64_tr_b16 v[228:229], v5 offset:5120
    ds_read_b64_tr_b16 v[230:231], v5 offset:7680
    buffer_load_dwordx4 v[100:103], v12, s[12:15], s58 offen offset:1024 sc1
    s_waitcnt lgkmcnt(10)
    v_mfma_f32_32x32x16_bf16 v[144:159], v[128:131], v[240:243], v[144:159]
    ds_read_b64_tr_b16 v[232:233], v5 offset:5184
    ds_read_b64_tr_b16 v[234:235], v5 offset:7744
    buffer_load_dwordx4 v[104:107], v12, s[12:15], s58 offen offset:2048 sc1
    s_waitcnt lgkmcnt(10)
    v_mfma_f32_32x32x16_bf16 v[160:175], v[128:131], v[244:247], v[160:175]
    ds_read_b64_tr_b16 v[236:237], v5 offset:5248
    ds_read_b64_tr_b16 v[238:239], v5 offset:7808
    buffer_load_dwordx4 v[108:111], v12, s[12:15], s58 offen offset:3072 sc1
    s_waitcnt lgkmcnt(10)
    v_mfma_f32_32x32x16_bf16 v[176:191], v[128:131], v[248:251], v[176:191]
    ds_read_b64_tr_b16 v[240:241], v5 offset:5312
    ds_read_b64_tr_b16 v[242:243], v5 offset:7872
    s_waitcnt lgkmcnt(10)
    v_mfma_f32_32x32x16_bf16 v[192:207], v[128:131], v[252:255], v[192:207]
    ds_read_b64_tr_b16 v[244:245], v5 offset:5376
    ds_read_b64_tr_b16 v[246:247], v5 offset:7936
    s_waitcnt lgkmcnt(10)
    v_mfma_f32_32x32x16_bf16 v[208:223], v[128:131], v[224:227], v[208:223]
    ds_read_b64_tr_b16 v[248:249], v5 offset:10240
    ds_read_b64_tr_b16 v[250:251], v5 offset:12800
    s_waitcnt lgkmcnt(10)
    v_mfma_f32_32x32x16_bf16 v[144:159], v[132:135], v[228:231], v[144:159]
    ds_read_b64_tr_b16 v[252:253], v5 offset:10304
    ds_read_b64_tr_b16 v[254:255], v5 offset:12864
    s_waitcnt lgkmcnt(10)
    v_mfma_f32_32x32x16_bf16 v[160:175], v[132:135], v[232:235], v[160:175]
    ds_read_b64_tr_b16 v[224:225], v5 offset:10368
    ds_read_b64_tr_b16 v[226:227], v5 offset:12928
    s_waitcnt lgkmcnt(10)
    v_mfma_f32_32x32x16_bf16 v[176:191], v[132:135], v[236:239], v[176:191]
    ds_read_b64_tr_b16 v[228:229], v5 offset:10432
    ds_read_b64_tr_b16 v[230:231], v5 offset:12992
    s_waitcnt lgkmcnt(10)
    v_mfma_f32_32x32x16_bf16 v[192:207], v[132:135], v[240:243], v[192:207]
    ds_read_b64_tr_b16 v[232:233], v5 offset:10496
    ds_read_b64_tr_b16 v[234:235], v5 offset:13056
    s_waitcnt lgkmcnt(10)
    v_mfma_f32_32x32x16_bf16 v[208:223], v[132:135], v[244:247], v[208:223]
    ds_read_b64_tr_b16 v[236:237], v5 offset:15360
    ds_read_b64_tr_b16 v[238:239], v5 offset:17920
    s_waitcnt vmcnt(0)
    s_add_u32 s55, s55, 128
    v_mov_b32 v10, s6
    v_mov_b32 v11, s7
    v_lshlrev_b32 v3, 3, v1
    s_mov_b64 exec, 0xffff
    buffer_store_dwordx2 v[10:11], v3, s[12:15], s55 offen sc1
    s_mov_b64 exec, -1
    v_lshrrev_b32 v3, 5, v1
    s_waitcnt lgkmcnt(10)
    v_mfma_f32_32x32x16_bf16 v[144:159], v[136:139], v[248:251], v[144:159]
    ds_read_b64_tr_b16 v[240:241], v5 offset:15424
    ds_read_b64_tr_b16 v[242:243], v5 offset:17984
    s_waitcnt lgkmcnt(10)
    v_mfma_f32_32x32x16_bf16 v[160:175], v[136:139], v[252:255], v[160:175]
    ds_read_b64_tr_b16 v[244:245], v5 offset:15488
    ds_read_b64_tr_b16 v[246:247], v5 offset:18048
    s_waitcnt lgkmcnt(10)
    v_mfma_f32_32x32x16_bf16 v[176:191], v[136:139], v[224:227], v[176:191]
    ds_read_b64_tr_b16 v[248:249], v5 offset:15552
    ds_read_b64_tr_b16 v[250:251], v5 offset:18112
    s_waitcnt lgkmcnt(10)
    v_mfma_f32_32x32x16_bf16 v[192:207], v[136:139], v[228:231], v[192:207]
    ds_read_b64_tr_b16 v[252:253], v5 offset:15616
    ds_read_b64_tr_b16 v[254:255], v5 offset:18176
    s_waitcnt lgkmcnt(10)
    v_mfma_f32_32x32x16_bf16 v[208:223], v[136:139], v[232:235], v[208:223]
    s_barrier
    s_add_u32 s62, s43, 2
    s_and_b32 s62, s62, 7
    s_lshl_b32 s62, s62, 2
    s_lshr_b32 s62, 0x1234567, s62
    s_and_b32 s62, s62, 7
    s_mul_i32 s62, s62, 20480
    v_add_u32 v6, s62, v9
    ds_read_b64_tr_b16 v[224:225], v6 offset:0
    ds_read_b64_tr_b16 v[226:227], v6 offset:2560
    s_waitcnt lgkmcnt(10)
    v_mfma_f32_32x32x16_bf16 v[144:159], v[140:143], v[236:239], v[144:159]
    ds_read_b64_tr_b16 v[228:229], v6 offset:64
    ds_read_b64_tr_b16 v[230:231], v6 offset:2624
    s_waitcnt lgkmcnt(10)
    v_mfma_f32_32x32x16_bf16 v[160:175], v[140:143], v[240:243], v[160:175]
    ds_read_b64_tr_b16 v[232:233], v6 offset:128
    ds_read_b64_tr_b16 v[234:235], v6 offset:2688
    s_waitcnt lgkmcnt(10)
    v_mfma_f32_32x32x16_bf16 v[176:191], v[140:143], v[244:247], v[176:191]
    ds_read_b64_tr_b16 v[236:237], v6 offset:192
    ds_read_b64_tr_b16 v[238:239], v6 offset:2752
    s_waitcnt lgkmcnt(10)
    v_mfma_f32_32x32x16_bf16 v[192:207], v[140:143], v[248:251], v[192:207]
    ds_read_b64_tr_b16 v[240:241], v6 offset:256
    ds_read_b64_tr_b16 v[242:243], v6 offset:2816
    s_waitcnt lgkmcnt(10)
    v_mfma_f32_32x32x16_bf16 v[208:223], v[140:143], v[252:255], v[208:223]
    ds_read_b64_tr_b16 v[244:245], v6 offset:5120
    ds_read_b64_tr_b16 v[246:247], v6 offset:7680
    s_waitcnt lgkmcnt(10)
    v_mfma_f32_32x32x16_bf16 v[144:159], v[64:67], v[224:227], v[144:159]
    ds_read_b64_tr_b16 v[248:249], v6 offset:5184
    ds_read_b64_tr_b16 v[250:251], v6 offset:7744
    s_waitcnt lgkmcnt(10)
    v_mfma_f32_32x32x16_bf16 v[160:175], v[64:67], v[228:231], v[160:175]
    ds_read_b64_tr_b16 v[252:253], v6 offset:5248
    ds_read_b64_tr_b16 v[254:255], v6 offset:7808
    s_waitcnt lgkmcnt(10)
    v_mfma_f32_32x32x16_bf16 v[176:191], v[64:67], v[232:235], v[176:191]
    ds_read_b64_tr_b16 v[224:225], v6 offset:5312
    ds_read_b64_tr_b16 v[226:227], v6 offset:7872
    s_waitcnt lgkmcnt(10)
    v_mfma_f32_32x32x16_bf16 v[192:207], v[64:67], v[236:239], v[192:207]
    ds_read_b64_tr_b16 v[228:229], v6 offset:5376
    ds_read_b64_tr_b16 v[230:231], v6 offset:7936
    s_waitcnt lgkmcnt(10)
    v_mfma_f32_32x32x16_bf16 v[208:223], v[64:67], v[240:243], v[208:223]
    ds_read_b64_tr_b16 v[232:233], v6 offset:10240
    ds_read_b64_tr_b16 v[234:235], v6 offset:12800
    s_waitcnt lgkmcnt(10)
    v_mfma_f32_32x32x16_bf16 v[144:159], v[68:71], v[244:247], v[144:159]
    ds_read_b64_tr_b16 v[236:237], v6 offset:10304
    ds_read_b64_tr_b16 v[238:239], v6 offset:12864
    s_waitcnt lgkmcnt(10)
    v_mfma_f32_32x32x16_bf16 v[160:175], v[68:71], v[248:251], v[160:175]
    ds_read_b64_tr_b16 v[240:241], v6 offset:10368
    ds_read_b64_tr_b16 v[242:243], v6 offset:12928
    s_waitcnt lgkmcnt(10)
    v_mfma_f32_32x32x16_bf16 v[176:191], v[68:71], v[252:255], v[176:191]
    ds_read_b64_tr_b16 v[244:245], v6 offset:10432
    ds_read_b64_tr_b16 v[246:247], v6 offset:12992
    s_waitcnt lgkmcnt(10)
    v_mfma_f32_32x32x16_bf16 v[192:207], v[68:71], v[224:227], v[192:207]
    ds_read_b64_tr_b16 v[248:249], v6 offset:10496
    ds_read_b64_tr_b16 v[250:251], v6 offset:13056
    s_waitcnt lgkmcnt(10)
    v_mfma_f32_32x32x16_bf16 v[208:223], v[68:71], v[228:231], v[208:223]
    ds_read_b64_tr_b16 v[252:253], v6 offset:15360
    ds_read_b64_tr_b16 v[254:255], v6 offset:17920
    s_waitcnt lgkmcnt(10)
    v_mfma_f32_32x32x16_bf16 v[144:159], v[72:75], v[232:235], v[144:159]
    ds_read_b64_tr_b16 v[224:225], v6 offset:15424
    ds_read_b64_tr_b16 v[226:227], v6 offset:17984
    s_waitcnt lgkmcnt(10)
    v_mfma_f32_32x32x16_bf16 v[160:175], v[72:75], v[236:239], v[160:175]
    ds_read_b64_tr_b16 v[228:229], v6 offset:15488
    ds_read_b64_tr_b16 v[230:231], v6 offset:18048
    s_waitcnt lgkmcnt(10)
    v_mfma_f32_32x32x16_bf16 v[176:191], v[72:75], v[240:243], v[176:191]
    ds_read_b64_tr_b16 v[232:233], v6 offset:15552
    ds_read_b64_tr_b16 v[234:235], v6 offset:18112
    s_waitcnt lgkmcnt(10)
    v_mfma_f32_32x32x16_bf16 v[192:207], v[72:75], v[244:247], v[192:207]
    ds_read_b64_tr_b16 v[236:237], v6 offset:15616
    ds_read_b64_tr_b16 v[238:239], v6 offset:18176
    s_waitcnt lgkmcnt(10)
    v_mfma_f32_32x32x16_bf16 v[208:223], v[72:75], v[248:251], v[208:223]
    s_add_u32 s62, s43, 3
    s_and_b32 s62, s62, 7
    s_lshl_b32 s62, s62, 2
    s_lshr_b32 s62, 0x1234567, s62
    s_and_b32 s62, s62, 7
    s_mul_i32 s62, s62, 20480
    v_add_u32 v4, s62, v9
    ds_read_b64_tr_b16 v[240:241], v4 offset:0
    ds_read_b64_tr_b16 v[242:243], v4 offset:2560
    s_waitcnt lgkmcnt(10)
    v_mfma_f32_32x32x16_bf16 v[144:159], v[76:79], v[252:255], v[144:159]
    ds_read_b64_tr_b16 v[244:245], v4 offset:64
    ds_read_b64_tr_b16 v[246:247], v4 offset:2624
    s_waitcnt lgkmcnt(10)
    v_mfma_f32_32x32x16_bf16 v[160:175], v[76:79], v[224:227], v[160:175]
    ds_read_b64_tr_b16 v[248:249], v4 offset:128
    ds_read_b64_tr_b16 v[250:251], v4 offset:2688
    s_waitcnt lgkmcnt(10)
    v_mfma_f32_32x32x16_bf16 v[176:191], v[76:79], v[228:231], v[176:191]
    ds_read_b64_tr_b16 v[252:253], v4 offset:192
    ds_read_b64_tr_b16 v[254:255], v4 offset:2752
    s_waitcnt lgkmcnt(10)
    v_mfma_f32_32x32x16_bf16 v[192:207], v[76:79], v[232:235], v[192:207]
    ds_read_b64_tr_b16 v[224:225], v4 offset:256
    ds_read_b64_tr_b16 v[226:227], v4 offset:2816
    s_waitcnt lgkmcnt(10)
    v_mfma_f32_32x32x16_bf16 v[208:223], v[76:79], v[236:239], v[208:223]
    ds_read_b64_tr_b16 v[228:229], v4 offset:5120
    ds_read_b64_tr_b16 v[230:231], v4 offset:7680
    s_mov_b64 exec, 15
    buffer_load_dwordx2 v[14:15], v13, s[12:15], s53 offen offset:128 sc1
    s_mov_b64 exec, -1
    s_waitcnt lgkmcnt(10)
    v_mfma_f32_32x32x16_bf16 v[144:159], v[80:83], v[240:243], v[144:159]
    ds_read_b64_tr_b16 v[232:233], v4 offset:5184
    ds_read_b64_tr_b16 v[234:235], v4 offset:7744
    s_waitcnt lgkmcnt(10)
    v_mfma_f32_32x32x16_bf16 v[160:175], v[80:83], v[244:247], v[160:175]
    ds_read_b64_tr_b16 v[236:237], v4 offset:5248
    ds_read_b64_tr_b16 v[238:239], v4 offset:7808
    s_waitcnt lgkmcnt(10)
    v_mfma_f32_32x32x16_bf16 v[176:191], v[80:83], v[248:251], v[176:191]
    ds_read_b64_tr_b16 v[240:241], v4 offset:5312
    ds_read_b64_tr_b16 v[242:243], v4 offset:7872
    s_waitcnt lgkmcnt(10)
    v_mfma_f32_32x32x16_bf16 v[192:207], v[80:83], v[252:255], v[192:207]
    ds_read_b64_tr_b16 v[244:245], v4 offset:5376
    ds_read_b64_tr_b16 v[246:247], v4 offset:7936
    s_waitcnt lgkmcnt(10)
    v_mfma_f32_32x32x16_bf16 v[208:223], v[80:83], v[224:227], v[208:223]
    ds_read_b64_tr_b16 v[248:249], v4 offset:10240
    ds_read_b64_tr_b16 v[250:251], v4 offset:12800
    s_waitcnt lgkmcnt(10)
    v_mfma_f32_32x32x16_bf16 v[144:159], v[84:87], v[228:231], v[144:159]
    ds_read_b64_tr_b16 v[252:253], v4 offset:10304
    ds_read_b64_tr_b16 v[254:255], v4 offset:12864
    s_waitcnt lgkmcnt(10)
    v_mfma_f32_32x32x16_bf16 v[160:175], v[84:87], v[232:235], v[160:175]
    ds_read_b64_tr_b16 v[224:225], v4 offset:10368
    ds_read_b64_tr_b16 v[226:227], v4 offset:12928
    s_waitcnt lgkmcnt(10)
    v_mfma_f32_32x32x16_bf16 v[176:191], v[84:87], v[236:239], v[176:191]
    ds_read_b64_tr_b16 v[228:229], v4 offset:10432
    ds_read_b64_tr_b16 v[230:231], v4 offset:12992
    s_waitcnt lgkmcnt(10)
    v_mfma_f32_32x32x16_bf16 v[192:207], v[84:87], v[240:243], v[192:207]
    ds_read_b64_tr_b16 v[232:233], v4 offset:10496
    ds_read_b64_tr_b16 v[234:235], v4 offset:13056
    s_waitcnt lgkmcnt(10)
    v_mfma_f32_32x32x16_bf16 v[208:223], v[84:87], v[244:247], v[208:223]
    ds_read_b64_tr_b16 v[236:237], v4 offset:15360
    ds_read_b64_tr_b16 v[238:239], v4 offset:17920
    s_waitcnt lgkmcnt(10)
    v_mfma_f32_32x32x16_bf16 v[144:159], v[88:91], v[248:251], v[144:159]
    ds_read_b64_tr_b16 v[240:241], v4 offset:15424
    ds_read_b64_tr_b16 v[242:243], v4 offset:17984
    s_waitcnt lgkmcnt(10)
    v_mfma_f32_32x32x16_bf16 v[160:175], v[88:91], v[252:255], v[160:175]
    ds_read_b64_tr_b16 v[244:245], v4 offset:15488
    ds_read_b64_tr_b16 v[246:247], v4 offset:18048
    s_waitcnt lgkmcnt(10)
    v_mfma_f32_32x32x16_bf16 v[176:191], v[88:91], v[224:227], v[176:191]
    ds_read_b64_tr_b16 v[248:249], v4 offset:15552
    ds_read_b64_tr_b16 v[250:251], v4 offset:18112
    s_waitcnt lgkmcnt(10)
    v_mfma_f32_32x32x16_bf16 v[192:207], v[88:91], v[228:231], v[192:207]
    ds_read_b64_tr_b16 v[252:253], v4 offset:15616
    ds_read_b64_tr_b16 v[254:255], v4 offset:18176
    s_waitcnt lgkmcnt(10)
    v_mfma_f32_32x32x16_bf16 v[208:223], v[88:91], v[232:235], v[208:223]
    s_add_u32 s62, s43, 4
    s_and_b32 s62, s62, 7
    s_lshl_b32 s62, s62, 2
    s_lshr_b32 s62, 0x1234567, s62
    s_and_b32 s62, s62, 7
    s_mul_i32 s62, s62, 20480
    v_add_u32 v5, s62, v9
    ds_read_b64_tr_b16 v[224:225], v5 offset:0
    ds_read_b64_tr_b16 v[226:227], v5 offset:2560
    s_waitcnt lgkmcnt(10)
    v_mfma_f32_32x32x16_bf16 v[144:159], v[92:95], v[236:239], v[144:159]
    ds_read_b64_tr_b16 v[228:229], v5 offset:64
    ds_read_b64_tr_b16 v[230:231], v5 offset:2624
    s_waitcnt lgkmcnt(10)
    v_mfma_f32_32x32x16_bf16 v[160:175], v[92:95], v[240:243], v[160:175]
    ds_read_b64_tr_b16 v[232:233], v5 offset:128
    ds_read_b64_tr_b16 v[234:235], v5 offset:2688
    s_waitcnt lgkmcnt(10)
    v_mfma_f32_32x32x16_bf16 v[176:191], v[92:95], v[244:247], v[176:191]
    ds_read_b64_tr_b16 v[236:237], v5 offset:192
    ds_read_b64_tr_b16 v[238:239], v5 offset:2752
    s_waitcnt lgkmcnt(10)
    v_mfma_f32_32x32x16_bf16 v[192:207], v[92:95], v[248:251], v[192:207]
    ds_read_b64_tr_b16 v[240:241], v5 offset:256
    ds_read_b64_tr_b16 v[242:243], v5 offset:2816
    s_waitcnt lgkmcnt(10)
    v_mfma_f32_32x32x16_bf16 v[208:223], v[92:95], v[252:255], v[208:223]
    ds_read_b64_tr_b16 v[244:245], v5 offset:5120
    ds_read_b64_tr_b16 v[246:247], v5 offset:7680
    s_mov_b64 exec, 15
    s_mov_b32 s40, 0
    s_branch pollc_35
poll_33:
    buffer_load_dwordx2 v[14:15], v13, s[12:15], s53 offen offset:128 sc1
pollc_35:
    s_waitcnt vmcnt(0)
    v_cmp_ne_u64 vcc, s[6:7], v[14:15]
    s_add_u32 s40, s40, 1
    s_cbranch_vccz pollx_34
    s_sleep 2
    s_cmp_lt_u32 s40, 400000
    s_cbranch_scc1 poll_33
pollx_34:
    s_mov_b64 exec, -1
    s_waitcnt lgkmcnt(10)
    v_mfma_f32_32x32x16_bf16 v[144:159], v[96:99], v[224:227], v[144:159]
    ds_read_b64_tr_b16 v[248:249], v5 offset:5184
    ds_read_b64_tr_b16 v[250:251], v5 offset:7744
    buffer_load_dwordx4 v[16:19], v12, s[12:15], s59 offen offset:0 sc1
    s_waitcnt lgkmcnt(10)
    v_mfma_f32_32x32x16_bf16 v[160:175], v[96:99], v[228:231], v[160:175]
    ds_read_b64_tr_b16 v[252:253], v5 offset:5248
    ds_read_b64_tr_b16 v[254:255], v5 offset:7808
    buffer_load_dwordx4 v[20:23], v12, s[12:15], s59 offen offset:1024 sc1
    s_waitcnt lgkmcnt(10)
    v_mfma_f32_32x32x16_bf16 v[176:191], v[96:99], v[232:235], v[176:191]
    ds_read_b64_tr_b16 v[224:225], v5 offset:5312
    ds_read_b64_tr_b16 v[226:227], v5 offset:7872
    buffer_load_dwordx4 v[24:27], v12, s[12:15], s59 offen offset:2048 sc1
    s_waitcnt lgkmcnt(10)
    v_mfma_f32_32x32x16_bf16 v[192:207], v[96:99], v[236:239], v[192:207]
    ds_read_b64_tr_b16 v[228:229], v5 offset:5376
    ds_read_b64_tr_b16 v[230:231], v5 offset:7936
    buffer_load_dwordx4 v[28:31], v12, s[12:15], s59 offen offset:3072 sc1
    s_waitcnt lgkmcnt(10)
    v_mfma_f32_32x32x16_bf16 v[208:223], v[96:99], v[240:243], v[208:223]
    ds_read_b64_tr_b16 v[232:233], v5 offset:10240
    ds_read_b64_tr_b16 v[234:235], v5 offset:12800
    buffer_load_dwordx4 v[32:35], v12, s[12:15], s60 offen offset:0 sc1
    s_waitcnt lgkmcnt(10)
    v_mfma_f32_32x32x16_bf16 v[144:159], v[100:103], v[244:247], v[144:159]
    ds_read_b64_tr_b16 v[236:237], v5 offset:10304
    ds_read_b64_tr_b16 v[238:239], v5 offset:12864
    buffer_load_dwordx4 v[36:39], v12, s[12:15], s60 offen offset:1024 sc1
    s_waitcnt lgkmcnt(10)
    v_mfma_f32_32x32x16_bf16 v[160:175], v[100:103], v[248:251], v[160:175]
    ds_read_b64_tr_b16 v[240:241], v5 offset:10368
    ds_read_b64_tr_b16 v[242:243], v5 offset:12928
    buffer_load_dwordx4 v[40:43], v12, s[12:15], s60 offen offset:2048 sc1
    s_waitcnt lgkmcnt(10)
    v_mfma_f32_32x32x16_bf16 v[176:191], v[100:103], v[252:255], v[176:191]
    ds_read_b64_tr_b16 v[244:245], v5 offset:10432
    ds_read_b64_tr_b16 v[246:247], v5 offset:12992
    buffer_load_dwordx4 v[44:47], v12, s[12:15], s60 offen offset:3072 sc1
    s_waitcnt lgkmcnt(10)
    v_mfma_f32_32x32x16_bf16 v[192:207], v[100:103], v[224:227], v[192:207]
    ds_read_b64_tr_b16 v[248:249], v5 offset:10496
    ds_read_b64_tr_b16 v[250:251], v5 offset:13056
    buffer_load_dwordx4 v[48:51], v12, s[12:15], s61 offen offset:0 sc1
    s_waitcnt lgkmcnt(10)
    v_mfma_f32_32x32x16_bf16 v[208:223], v[100:103], v[228:231], v[208:223]
    ds_read_b64_tr_b16 v[252:253], v5 offset:15360
    ds_read_b64_tr_b16 v[254:255], v5 offset:17920
    buffer_load_dwordx4 v[52:55], v12, s[12:15], s61 offen offset:1024 sc1
    s_waitcnt lgkmcnt(10)
    v_mfma_f32_32x32x16_bf16 v[144:159], v[104:107], v[232:235], v[144:159]
    ds_read_b64_tr_b16 v[224:225], v5 offset:15424
    ds_read_b64_tr_b16 v[226:227], v5 offset:17984
    buffer_load_dwordx4 v[56:59], v12, s[12:15], s61 offen offset:2048 sc1
    s_waitcnt lgkmcnt(10)
    v_mfma_f32_32x32x16_bf16 v[160:175], v[104:107], v[236:239], v[160:175]
    ds_read_b64_tr_b16 v[228:229], v5 offset:15488
    ds_read_b64_tr_b16 v[230:231], v5 offset:18048
    buffer_load_dwordx4 v[60:63], v12, s[12:15], s61 offen offset:3072 sc1
    s_waitcnt lgkmcnt(10)
    v_mfma_f32_32x32x16_bf16 v[176:191], v[104:107], v[240:243], v[176:191]
    ds_read_b64_tr_b16 v[232:233], v5 offset:15552
    ds_read_b64_tr_b16 v[234:235], v5 offset:18112
    s_waitcnt lgkmcnt(10)
    v_mfma_f32_32x32x16_bf16 v[192:207], v[104:107], v[244:247], v[192:207]
    ds_read_b64_tr_b16 v[236:237], v5 offset:15616
    ds_read_b64_tr_b16 v[238:239], v5 offset:18176
    s_waitcnt lgkmcnt(10)
    v_mfma_f32_32x32x16_bf16 v[208:223], v[104:107], v[248:251], v[208:223]
    s_add_u32 s62, s43, 5
    s_and_b32 s62, s62, 7
    s_lshl_b32 s62, s62, 2
    s_lshr_b32 s62, 0x1234567, s62
    s_and_b32 s62, s62, 7
    s_mul_i32 s62, s62, 20480
    v_add_u32 v6, s62, v9
    ds_read_b64_tr_b16 v[240:241], v6 offset:0
    ds_read_b64_tr_b16 v[242:243], v6 offset:2560
    s_waitcnt lgkmcnt(10)
    v_mfma_f32_32x32x16_bf16 v[144:159], v[108:111], v[252:255], v[144:159]
    ds_read_b64_tr_b16 v[244:245], v6 offset:5120
    ds_read_b64_tr_b16 v[246:247], v6 offset:7680
    s_waitcnt lgkmcnt(10)
    v_mfma_f32_32x32x16_bf16 v[160:175], v[108:111], v[224:227], v[160:175]
    ds_read_b64_tr_b16 v[248:249], v6 offset:10240
    ds_read_b64_tr_b16 v[250:251], v6 offset:12800
    s_waitcnt lgkmcnt(10)
    v_mfma_f32_32x32x16_bf16 v[176:191], v[108:111], v[228:231], v[176:191]
    ds_read_b64_tr_b16 v[252:253], v6 offset:15360
    ds_read_b64_tr_b16 v[254:255], v6 offset:17920
    s_waitcnt lgkmcnt(10)
    v_mfma_f32_32x32x16_bf16 v[192:207], v[108:111], v[232:235], v[192:207]
    s_add_u32 s62, s43, 6
    s_and_b32 s62, s62, 7
    s_lshl_b32 s62, s62, 2
    s_lshr_b32 s62, 0x1234567, s62
    s_and_b32 s62, s62, 7
    s_mul_i32 s62, s62, 20480
    v_add_u32 v4, s62, v9
    ds_read_b64_tr_b16 v[224:225], v4 offset:0
    ds_read_b64_tr_b16 v[226:227], v4 offset:2560
    s_waitcnt lgkmcnt(10)
    v_mfma_f32_32x32x16_bf16 v[208:223], v[108:111], v[236:239], v[208:223]
    ds_read_b64_tr_b16 v[228:229], v4 offset:5120
    ds_read_b64_tr_b16 v[230:231], v4 offset:7680
    s_waitcnt vmcnt(11) lgkmcnt(10)
    v_mfma_f32_32x32x16_bf16 v[144:159], v[16:19], v[240:243], v[144:159]
    ds_read_b64_tr_b16 v[232:233], v4 offset:10240
    ds_read_b64_tr_b16 v[234:235], v4 offset:12800
    s_waitcnt vmcnt(10) lgkmcnt(10)
    v_mfma_f32_32x32x16_bf16 v[144:159], v[20:23], v[244:247], v[144:159]
    ds_read_b64_tr_b16 v[236:237], v4 offset:15360
    ds_read_b64_tr_b16 v[238:239], v4 offset:17920
    s_waitcnt vmcnt(9) lgkmcnt(10)
    v_mfma_f32_32x32x16_bf16 v[144:159], v[24:27], v[248:251], v[144:159]
    s_add_u32 s62, s43, 7
    s_and_b32 s62, s62, 7
    s_lshl_b32 s62, s62, 2
    s_lshr_b32 s62, 0x1234567, s62
    s_and_b32 s62, s62, 7
    s_mul_i32 s62, s62, 20480
    v_add_u32 v5, s62, v9
    ds_read_b64_tr_b16 v[240:241], v5 offset:0
    ds_read_b64_tr_b16 v[242:243], v5 offset:2560
    s_waitcnt vmcnt(8) lgkmcnt(10)
    v_mfma_f32_32x32x16_bf16 v[144:159], v[28:31], v[252:255], v[144:159]
    ds_read_b64_tr_b16 v[244:245], v5 offset:5120
    ds_read_b64_tr_b16 v[246:247], v5 offset:7680
    s_waitcnt vmcnt(7) lgkmcnt(10)
    v_mfma_f32_32x32x16_bf16 v[144:159], v[32:35], v[224:227], v[144:159]
    ds_read_b64_tr_b16 v[248:249], v5 offset:10240
    ds_read_b64_tr_b16 v[250:251], v5 offset:12800
    s_waitcnt vmcnt(6) lgkmcnt(10)
    v_mfma_f32_32x32x16_bf16 v[144:159], v[36:39], v[228:231], v[144:159]
    ds_read_b64_tr_b16 v[252:253], v5 offset:15360
    ds_read_b64_tr_b16 v[254:255], v5 offset:17920
    s_waitcnt vmcnt(5) lgkmcnt(10)
    v_mfma_f32_32x32x16_bf16 v[144:159], v[40:43], v[232:235], v[144:159]
    ds_read_b64_tr_b16 v[224:225], v6 offset:64
    ds_read_b64_tr_b16 v[226:227], v6 offset:2624
    s_waitcnt vmcnt(4) lgkmcnt(10)
    v_mfma_f32_32x32x16_bf16 v[144:159], v[44:47], v[236:239], v[144:159]
    ds_read_b64_tr_b16 v[228:229], v6 offset:5184
    ds_read_b64_tr_b16 v[230:231], v6 offset:7744
    s_waitcnt vmcnt(3) lgkmcnt(10)
    v_mfma_f32_32x32x16_bf16 v[144:159], v[48:51], v[240:243], v[144:159]
    ds_read_b64_tr_b16 v[232:233], v6 offset:10304
    ds_read_b64_tr_b16 v[234:235], v6 offset:12864
    s_waitcnt vmcnt(2) lgkmcnt(10)
    v_mfma_f32_32x32x16_bf16 v[144:159], v[52:55], v[244:247], v[144:159]
    ds_read_b64_tr_b16 v[236:237], v6 offset:15424
    ds_read_b64_tr_b16 v[238:239], v6 offset:17984
    s_waitcnt vmcnt(1) lgkmcnt(10)
    v_mfma_f32_32x32x16_bf16 v[144:159], v[56:59], v[248:251], v[144:159]
    ds_read_b64_tr_b16 v[240:241], v4 offset:64
    ds_read_b64_tr_b16 v[242:243], v4 offset:2624
    s_waitcnt vmcnt(0) lgkmcnt(10)
    v_mfma_f32_32x32x16_bf16 v[144:159], v[60:63], v[252:255], v[144:159]
    ds_read_b64_tr_b16 v[244:245], v4 offset:5184
    ds_read_b64_tr_b16 v[246:247], v4 offset:7744
    s_waitcnt lgkmcnt(10)
    v_mfma_f32_32x32x16_bf16 v[160:175], v[16:19], v[224:227], v[160:175]
    ds_read_b64_tr_b16 v[248:249], v4 offset:10304
    ds_read_b64_tr_b16 v[250:251], v4 offset:12864
    s_waitcnt lgkmcnt(10)
    v_mfma_f32_32x32x16_bf16 v[160:175], v[20:23], v[228:231], v[160:175]
    ds_read_b64_tr_b16 v[252:253], v4 offset:15424
    ds_read_b64_tr_b16 v[254:255], v4 offset:17984
    s_waitcnt lgkmcnt(10)
    v_mfma_f32_32x32x16_bf16 v[160:175], v[24:27], v[232:235], v[160:175]
    ds_read_b64_tr_b16 v[224:225], v5 offset:64
    ds_read_b64_tr_b16 v[226:227], v5 offset:2624
    v_cvt_pk_bf16_f32 v112, v144, v145
    v_cvt_pk_bf16_f32 v113, v146, v147
    s_waitcnt lgkmcnt(10)
    v_mfma_f32_32x32x16_bf16 v[160:175], v[28:31], v[236:239], v[160:175]
    ds_read_b64_tr_b16 v[228:229], v5 offset:5184
    ds_read_b64_tr_b16 v[230:231], v5 offset:7744
    v_cvt_pk_bf16_f32 v114, v148, v149
    v_cvt_pk_bf16_f32 v115, v150, v151
    s_waitcnt lgkmcnt(10)
    v_mfma_f32_32x32x16_bf16 v[160:175], v[32:35], v[240:243], v[160:175]
    ds_read_b64_tr_b16 v[232:233], v5 offset:10304
    ds_read_b64_tr_b16 v[234:235], v5 offset:12864
    buffer_store_dwordx4 v[112:115], v7, s[12:15], s52 offen offset:0 sc1
    v_cvt_pk_bf16_f32 v116, v152, v153
    s_waitcnt lgkmcnt(10)
    v_mfma_f32_32x32x16_bf16 v[160:175], v[36:39], v[244:247], v[160:175]
    ds_read_b64_tr_b16 v[236:237], v5 offset:15424
    ds_read_b64_tr_b16 v[238:239], v5 offset:17984
    v_cvt_pk_bf16_f32 v117, v154, v155
    v_cvt_pk_bf16_f32 v118, v156, v157
    s_waitcnt lgkmcnt(10)
    v_mfma_f32_32x32x16_bf16 v[160:175], v[40:43], v[248:251], v[160:175]
    ds_read_b64_tr_b16 v[240:241], v6 offset:128
    ds_read_b64_tr_b16 v[242:243], v6 offset:2688
    v_cvt_pk_bf16_f32 v119, v158, v159
    s_add_u32 s51, s52, 20480
    s_waitcnt lgkmcnt(10)
    v_mfma_f32_32x32x16_bf16 v[160:175], v[44:47], v[252:255], v[160:175]
    ds_read_b64_tr_b16 v[244:245], v6 offset:5248
    ds_read_b64_tr_b16 v[246:247], v6 offset:7808
    buffer_store_dwordx4 v[116:119], v7, s[12:15], s51 offen offset:0 sc1
    s_waitcnt lgkmcnt(10)
    v_mfma_f32_32x32x16_bf16 v[160:175], v[48:51], v[224:227], v[160:175]
    ds_read_b64_tr_b16 v[248:249], v6 offset:10368
    ds_read_b64_tr_b16 v[250:251], v6 offset:12928
    s_waitcnt lgkmcnt(10)
    v_mfma_f32_32x32x16_bf16 v[160:175], v[52:55], v[228:231], v[160:175]
    ds_read_b64_tr_b16 v[252:253], v6 offset:15488
    ds_read_b64_tr_b16 v[254:255], v6 offset:18048
    s_waitcnt lgkmcnt(10)
    v_mfma_f32_32x32x16_bf16 v[160:175], v[56:59], v[232:235], v[160:175]
    ds_read_b64_tr_b16 v[224:225], v4 offset:128
    ds_read_b64_tr_b16 v[226:227], v4 offset:2688
    s_waitcnt lgkmcnt(10)
    v_mfma_f32_32x32x16_bf16 v[160:175], v[60:63], v[236:239], v[160:175]
    ds_read_b64_tr_b16 v[228:229], v4 offset:5248
    ds_read_b64_tr_b16 v[230:231], v4 offset:7808
    s_waitcnt lgkmcnt(10)
    v_mfma_f32_32x32x16_bf16 v[176:191], v[16:19], v[240:243], v[176:191]
    ds_read_b64_tr_b16 v[232:233], v4 offset:10368
    ds_read_b64_tr_b16 v[234:235], v4 offset:12928
    s_waitcnt lgkmcnt(10)
    v_mfma_f32_32x32x16_bf16 v[176:191], v[20:23], v[244:247], v[176:191]
    ds_read_b64_tr_b16 v[236:237], v4 offset:15488
    ds_read_b64_tr_b16 v[238:239], v4 offset:18048
    s_waitcnt lgkmcnt(10)
    v_mfma_f32_32x32x16_bf16 v[176:191], v[24:27], v[248:251], v[176:191]
    ds_read_b64_tr_b16 v[240:241], v5 offset:128
    ds_read_b64_tr_b16 v[242:243], v5 offset:2688
    v_cvt_pk_bf16_f32 v120, v160, v161
    v_cvt_pk_bf16_f32 v121, v162, v163
    s_waitcnt lgkmcnt(10)
    v_mfma_f32_32x32x16_bf16 v[176:191], v[28:31], v[252:255], v[176:191]
    ds_read_b64_tr_b16 v[244:245], v5 offset:5248
    ds_read_b64_tr_b16 v[246:247], v5 offset:7808
    v_cvt_pk_bf16_f32 v122, v164, v165
    v_cvt_pk_bf16_f32 v123, v166, v167
    s_waitcnt lgkmcnt(10)
    v_mfma_f32_32x32x16_bf16 v[176:191], v[32:35], v[224:227], v[176:191]
    ds_read_b64_tr_b16 v[248:249], v5 offset:10368
    ds_read_b64_tr_b16 v[250:251], v5 offset:12928
    buffer_store_dwordx4 v[120:123], v7, s[12:15], s52 offen offset:512 sc1
    v_cvt_pk_bf16_f32 v124, v168, v169
    s_waitcnt lgkmcnt(10)
    v_mfma_f32_32x32x16_bf16 v[176:191], v[36:39], v[228:231], v[176:191]
    ds_read_b64_tr_b16 v[252:253], v5 offset:15488
    ds_read_b64_tr_b16 v[254:255], v5 offset:18048
    v_cvt_pk_bf16_f32 v125, v170, v171
    v_cvt_pk_bf16_f32 v126, v172, v173
    s_waitcnt lgkmcnt(10)
    v_mfma_f32_32x32x16_bf16 v[176:191], v[40:43], v[232:235], v[176:191]
    ds_read_b64_tr_b16 v[224:225], v6 offset:192
    ds_read_b64_tr_b16 v[226:227], v6 offset:2752
    v_cvt_pk_bf16_f32 v127, v174, v175
    buffer_store_dwordx4 v[124:127], v7, s[12:15], s51 offen offset:512 sc1
    s_waitcnt lgkmcnt(10)
    v_mfma_f32_32x32x16_bf16 v[176:191], v[44:47], v[236:239], v[176:191]
    ds_read_b64_tr_b16 v[228:229], v6 offset:5312
    ds_read_b64_tr_b16 v[230:231], v6 offset:7872
    s_waitcnt lgkmcnt(10)
    v_mfma_f32_32x32x16_bf16 v[176:191], v[48:51], v[240:243], v[176:191]
    ds_read_b64_tr_b16 v[232:233], v6 offset:10432
    ds_read_b64_tr_b16 v[234:235], v6 offset:12992
    s_waitcnt lgkmcnt(10)
    v_mfma_f32_32x32x16_bf16 v[176:191], v[52:55], v[244:247], v[176:191]
    ds_read_b64_tr_b16 v[236:237], v6 offset:15552
    ds_read_b64_tr_b16 v[238:239], v6 offset:18112
    s_waitcnt lgkmcnt(10)
    v_mfma_f32_32x32x16_bf16 v[176:191], v[56:59], v[248:251], v[176:191]
    ds_read_b64_tr_b16 v[240:241], v4 offset:192
    ds_read_b64_tr_b16 v[242:243], v4 offset:2752
    s_waitcnt lgkmcnt(10)
    v_mfma_f32_32x32x16_bf16 v[176:191], v[60:63], v[252:255], v[176:191]
    ds_read_b64_tr_b16 v[244:245], v4 offset:5312
    ds_read_b64_tr_b16 v[246:247], v4 offset:7872
    s_waitcnt lgkmcnt(10)
    v_mfma_f32_32x32x16_bf16 v[192:207], v[16:19], v[224:227], v[192:207]
    ds_read_b64_tr_b16 v[248:249], v4 offset:10432
    ds_read_b64_tr_b16 v[250:251], v4 offset:12992
    s_waitcnt lgkmcnt(10)
    v_mfma_f32_32x32x16_bf16 v[192:207], v[20:23], v[228:231], v[192:207]
    ds_read_b64_tr_b16 v[252:253], v4 offset:15552
    ds_read_b64_tr_b16 v[254:255], v4 offset:18112
    s_waitcnt lgkmcnt(10)
    v_mfma_f32_32x32x16_bf16 v[192:207], v[24:27], v[232:235], v[192:207]
    ds_read_b64_tr_b16 v[224:225], v5 offset:192
    ds_read_b64_tr_b16 v[226:227], v5 offset:2752
    v_cvt_pk_bf16_f32 v128, v176, v177
    v_cvt_pk_bf16_f32 v129, v178, v179
    s_waitcnt lgkmcnt(10)
    v_mfma_f32_32x32x16_bf16 v[192:207], v[28:31], v[236:239], v[192:207]
    ds_read_b64_tr_b16 v[228:229], v5 offset:5312
    ds_read_b64_tr_b16 v[230:231], v5 offset:7872
    v_cvt_pk_bf16_f32 v130, v180, v181
    v_cvt_pk_bf16_f32 v131, v182, v183
    s_waitcnt lgkmcnt(10)
    v_mfma_f32_32x32x16_bf16 v[192:207], v[32:35], v[240:243], v[192:207]
    ds_read_b64_tr_b16 v[232:233], v5 offset:10432
    ds_read_b64_tr_b16 v[234:235], v5 offset:12992
    buffer_store_dwordx4 v[128:131], v7, s[12:15], s52 offen offset:1024 sc1
    v_cvt_pk_bf16_f32 v132, v184, v185
    s_waitcnt lgkmcnt(10)
    v_mfma_f32_32x32x16_bf16 v[192:207], v[36:39], v[244:247], v[192:207]
    ds_read_b64_tr_b16 v[236:237], v5 offset:15552
    ds_read_b64_tr_b16 v[238:239], v5 offset:18112
    v_cvt_pk_bf16_f32 v133, v186, v187
    v_cvt_pk_bf16_f32 v134, v188, v189
    s_waitcnt lgkmcnt(10)
    v_mfma_f32_32x32x16_bf16 v[192:207], v[40:43], v[248:251], v[192:207]
    ds_read_b64_tr_b16 v[240:241], v6 offset:256
    ds_read_b64_tr_b16 v[242:243], v6 offset:2816
    v_cvt_pk_bf16_f32 v135, v190, v191
    buffer_store_dwordx4 v[132:135], v7, s[12:15], s51 offen offset:1024 sc1
    s_waitcnt lgkmcnt(10)
    v_mfma_f32_32x32x16_bf16 v[192:207], v[44:47], v[252:255], v[192:207]
    ds_read_b64_tr_b16 v[244:245], v6 offset:5376
    ds_read_b64_tr_b16 v[246:247], v6 offset:7936
    s_waitcnt lgkmcnt(10)
    v_mfma_f32_32x32x16_bf16 v[192:207], v[48:51], v[224:227], v[192:207]
    ds_read_b64_tr_b16 v[248:249], v6 offset:10496
    ds_read_b64_tr_b16 v[250:251], v6 offset:13056
    s_waitcnt lgkmcnt(10)
    v_mfma_f32_32x32x16_bf16 v[192:207], v[52:55], v[228:231], v[192:207]
    ds_read_b64_tr_b16 v[252:253], v6 offset:15616
    ds_read_b64_tr_b16 v[254:255], v6 offset:18176
    s_waitcnt lgkmcnt(10)
    v_mfma_f32_32x32x16_bf16 v[192:207], v[56:59], v[232:235], v[192:207]
    ds_read_b64_tr_b16 v[224:225], v4 offset:256
    ds_read_b64_tr_b16 v[226:227], v4 offset:2816
    s_waitcnt lgkmcnt(10)
    v_mfma_f32_32x32x16_bf16 v[192:207], v[60:63], v[236:239], v[192:207]
    ds_read_b64_tr_b16 v[228:229], v4 offset:5376
    ds_read_b64_tr_b16 v[230:231], v4 offset:7936
    s_waitcnt lgkmcnt(10)
    v_mfma_f32_32x32x16_bf16 v[208:223], v[16:19], v[240:243], v[208:223]
    ds_read_b64_tr_b16 v[232:233], v4 offset:10496
    ds_read_b64_tr_b16 v[234:235], v4 offset:13056
    s_waitcnt lgkmcnt(10)
    v_mfma_f32_32x32x16_bf16 v[208:223], v[20:23], v[244:247], v[208:223]
    ds_read_b64_tr_b16 v[236:237], v4 offset:15616
    ds_read_b64_tr_b16 v[238:239], v4 offset:18176
    s_waitcnt lgkmcnt(10)
    v_mfma_f32_32x32x16_bf16 v[208:223], v[24:27], v[248:251], v[208:223]
    ds_read_b64_tr_b16 v[240:241], v5 offset:256
    ds_read_b64_tr_b16 v[242:243], v5 offset:2816
    v_cvt_pk_bf16_f32 v136, v192, v193
    v_cvt_pk_bf16_f32 v137, v194, v195
    s_waitcnt lgkmcnt(10)
    v_mfma_f32_32x32x16_bf16 v[208:223], v[28:31], v[252:255], v[208:223]
    ds_read_b64_tr_b16 v[244:245], v5 offset:5376
    ds_read_b64_tr_b16 v[246:247], v5 offset:7936
    v_cvt_pk_bf16_f32 v138, v196, v197
    v_cvt_pk_bf16_f32 v139, v198, v199
    s_waitcnt lgkmcnt(10)
    v_mfma_f32_32x32x16_bf16 v[208:223], v[32:35], v[224:227], v[208:223]
    ds_read_b64_tr_b16 v[248:249], v5 offset:10496
    ds_read_b64_tr_b16 v[250:251], v5 offset:13056
    buffer_store_dwordx4 v[136:139], v7, s[12:15], s52 offen offset:1536 sc1
    v_cvt_pk_bf16_f32 v140, v200, v201
    s_waitcnt lgkmcnt(10)
    v_mfma_f32_32x32x16_bf16 v[208:223], v[36:39], v[228:231], v[208:223]
    ds_read_b64_tr_b16 v[252:253], v5 offset:15616
    ds_read_b64_tr_b16 v[254:255], v5 offset:18176
    v_cvt_pk_bf16_f32 v141, v202, v203
    v_cvt_pk_bf16_f32 v142, v204, v205
    s_waitcnt lgkmcnt(10)
    v_mfma_f32_32x32x16_bf16 v[208:223], v[40:43], v[232:235], v[208:223]
    v_cvt_pk_bf16_f32 v143, v206, v207
    buffer_store_dwordx4 v[140:143], v7, s[12:15], s51 offen offset:1536 sc1
    s_waitcnt lgkmcnt(8)
    v_mfma_f32_32x32x16_bf16 v[208:223], v[44:47], v[236:239], v[208:223]
    s_waitcnt lgkmcnt(6)
    v_mfma_f32_32x32x16_bf16 v[208:223], v[48:51], v[240:243], v[208:223]
    s_waitcnt lgkmcnt(4)
    v_mfma_f32_32x32x16_bf16 v[208:223], v[52:55], v[244:247], v[208:223]
    s_waitcnt lgkmcnt(2)
    v_mfma_f32_32x32x16_bf16 v[208:223], v[56:59], v[248:251], v[208:223]
    s_waitcnt lgkmcnt(0)
    v_mfma_f32_32x32x16_bf16 v[208:223], v[60:63], v[252:255], v[208:223]
    s_lshl_b32 s48, s44, 2
    s_add_u32 s48, s48, s3
    s_lshl_b32 s48, s48, 11
    s_add_u32 s48, s48, 25329664
    s_lshl_b32 s49, s47, 7
    s_add_u32 s48, s48, s49
    s_nop 5
    v_cvt_pk_bf16_f32 v64, v208, v209
    v_cvt_pk_bf16_f32 v65, v210, v211
    v_cvt_pk_bf16_f32 v66, v212, v213
    v_cvt_pk_bf16_f32 v67, v214, v215
    buffer_store_dwordx4 v[64:67], v7, s[12:15], s52 offen offset:2048 sc1
    v_cvt_pk_bf16_f32 v68, v216, v217
    v_cvt_pk_bf16_f32 v69, v218, v219
    v_cvt_pk_bf16_f32 v70, v220, v221
    v_cvt_pk_bf16_f32 v71, v222, v223
    buffer_store_dwordx4 v[68:71], v7, s[12:15], s51 offen offset:2048 sc1
    s_waitcnt vmcnt(0)
    v_mov_b32 v14, s6
    v_mov_b32 v15, s7
    v_lshlrev_b32 v3, 3, v1
    s_mov_b64 exec, 0xffff
    buffer_store_dwordx2 v[14:15], v3, s[12:15], s48 offen sc1
    s_mov_b64 exec, -1
    v_lshrrev_b32 v3, 5, v1
    s_branch L_fin
L_Fw:
    s_lshl_b32 s44, s4, 3
    s_add_u32 s44, s44, s5
    s_sub_u32 s44, s44, 24
    s_lshr_b32 s51, s44, 3
    s_lshl_b32 s51, s51, 7
    s_and_b32 s48, s44, 7
    s_lshl_b32 s48, s48, 2
    s_add_u32 s51, s51, s48
    s_and_b32 s48, s3, 1
    s_lshl_b32 s48, s48, 6
    s_add_u32 s51, s51, s48
    s_mul_i32 s51, s51, 642
    s_and_b32 s51, s51, -16
    s_mul_i32 m0, s3, 10496
    v_lshlrev_b32 v8, 4, v1
    s_waitcnt lgkmcnt(0)
    s_cmp_lt_u32 s3, 2
    s_cselect_b32 s48, s66, s68
    s_cselect_b32 s49, s67, s69
    s_mov_b32 s20, s48
    s_and_b32 s21, s49, 0xffff
    s_mov_b32 s22, 0x141000
    s_mov_b32 s23, 0x00020000
    s_mov_b32 exec_hi, 0x1ff
    s_add_u32 s52, s51, 0
    buffer_load_dwordx4 v8, s[20:23], s52 offen nt lds
    s_add_u32 m0, m0, 656
    s_add_u32 s52, s51, 640
    buffer_load_dwordx4 v8, s[20:23], s52 offen nt lds
    s_add_u32 m0, m0, 656
    s_add_u32 s52, s51, 1280
    buffer_load_dwordx4 v8, s[20:23], s52 offen nt lds
    s_add_u32 m0, m0, 656
    s_add_u32 s52, s51, 1920
    buffer_load_dwordx4 v8, s[20:23], s52 offen nt lds
    s_add_u32 m0, m0, 656
    s_add_u32 s52, s51, 657408
    buffer_load_dwordx4 v8, s[20:23], s52 offen nt lds
    s_add_u32 m0, m0, 656
    s_add_u32 s52, s51, 658048
    buffer_load_dwordx4 v8, s[20:23], s52 offen nt lds
    s_add_u32 m0, m0, 656
    s_add_u32 s52, s51, 658688
    buffer_load_dwordx4 v8, s[20:23], s52 offen nt lds
    s_add_u32 m0, m0, 656
    s_add_u32 s52, s51, 659328
    buffer_load_dwordx4 v8, s[20:23], s52 offen nt lds
    s_add_u32 m0, m0, 656
    s_add_u32 s52, s51, 20544
    buffer_load_dwordx4 v8, s[20:23], s52 offen nt lds
    s_add_u32 m0, m0, 656
    s_add_u32 s52, s51, 21184
    buffer_load_dwordx4 v8, s[20:23], s52 offen nt lds
    s_add_u32 m0, m0, 656
    s_add_u32 s52, s51, 21824
    buffer_load_dwordx4 v8, s[20:23], s52 offen nt lds
    s_add_u32 m0, m0, 656
    s_add_u32 s52, s51, 22464
    buffer_load_dwordx4 v8, s[20:23], s52 offen nt lds
    s_add_u32 m0, m0, 656
    s_add_u32 s52, s51, 677952
    buffer_load_dwordx4 v8, s[20:23], s52 offen nt lds
    s_add_u32 m0, m0, 656
    s_add_u32 s52, s51, 678592
    buffer_load_dwordx4 v8, s[20:23], s52 offen nt lds
    s_add_u32 m0, m0, 656
    s_add_u32 s52, s51, 679232
    buffer_load_dwordx4 v8, s[20:23], s52 offen nt lds
    s_add_u32 m0, m0, 656
    s_add_u32 s52, s51, 679872
    buffer_load_dwordx4 v8, s[20:23], s52 offen nt lds
    s_mov_b64 exec, -1
    s_setprio 0
    s_call_b64 s[38:39], L_consts
    s_mov_b32 s12, s84
    s_and_b32 s13, s85, 0xffff
    s_mov_b32 s14, 0x1848000
    s_mov_b32 s15, 0x00020000
    s_mov_b32 s28, s82
    s_and_b32 s29, s83, 0xffff
    s_mov_b32 s30, 0x100
    s_mov_b32 s31, 0x00020000
    v_and_b32 v8, 3, v0
    v_bfe_u32 v9, v0, 2, 1
    v_lshrrev_b32 v10, 3, v0
    v_mul_u32_u24 v21, 658, v8
    v_mul_u32_u24 v9, 2624, v9
    v_lshl_add_u32 v21, v10, 1, v21
    s_and_b32 s48, s44, 1
    s_lshl_b32 s48, s48, 3
    v_add3_u32 v21, v21, v9, s48
    v_and_b32 v8, 7, v0
    v_mul_u32_u24 v22, 8320, v10
    v_lshl_add_u32 v22, v8, 4, v22
    v_mov_b32 v12, 131072
    s_lshl_b32 s49, s44, 7
    s_add_u32 s49, s49, 3170304
    s_lshl_b32 s48, s3, 2
    v_add_u32 v8, s48, v12
    v_mov_b32 v9, 1
    s_waitcnt vmcnt(0)
    ds_write_b32 v8, v9 offset:48
    s_mov_b32 s40, 0
lw_36:
    ds_read_b128 v[24:27], v12 offset:48
    s_add_u32 s40, s40, 1
    s_waitcnt lgkmcnt(0)
    v_min3_u32 v24, v24, v25, v26
    v_min_u32 v24, v24, v27
    v_cmp_gt_u32 vcc, 1, v24
    s_cbranch_vccz lwx_37
    s_cmp_lt_u32 s40, 3200000
    s_cbranch_scc1 lw_36
lwx_37:
    ds_read_u16 v24, v21 offset:0
    ds_read_u16_d16_hi v28, v21 offset:20992
    ds_read_u16 v25, v21 offset:5248
    ds_read_u16_d16_hi v29, v21 offset:26240
    ds_read_u16 v26, v21 offset:10496
    ds_read_u16_d16_hi v30, v21 offset:31488
    ds_read_u16 v27, v21 offset:15744
    ds_read_u16_d16_hi v31, v21 offset:36736
    ds_read_u16 v32, v21 offset:64
    ds_read_u16_d16_hi v36, v21 offset:21056
    ds_read_u16 v33, v21 offset:5312
    ds_read_u16_d16_hi v37, v21 offset:26304
    ds_read_u16 v34, v21 offset:10560
    ds_read_u16_d16_hi v38, v21 offset:31552
    ds_read_u16 v35, v21 offset:15808
    s_waitcnt lgkmcnt(14)
    ds_read_u16_d16_hi v39, v21 offset:36800
    s_waitcnt lgkmcnt(8)
    v_or_b32 v24, v24, v28
    v_or_b32 v25, v25, v29
    v_or_b32 v26, v26, v30
    v_or_b32 v27, v27, v31
    buffer_store_dwordx4 v[24:27], v22, s[12:15], s49 offen sc1
    s_add_u32 s49, s49, 266240
    ds_read_u16 v40, v21 offset:128
    ds_read_u16_d16_hi v44, v21 offset:21120
    ds_read_u16 v41, v21 offset:5376
    ds_read_u16_d16_hi v45, v21 offset:26368
    ds_read_u16 v42, v21 offset:10624
    ds_read_u16_d16_hi v46, v21 offset:31616
    ds_read_u16 v43, v21 offset:15872
    s_waitcnt lgkmcnt(14)
    ds_read_u16_d16_hi v47, v21 offset:36864
    s_waitcnt lgkmcnt(8)
    v_or_b32 v32, v32, v36
    v_or_b32 v33, v33, v37
    v_or_b32 v34, v34, v38
    v_or_b32 v35, v35, v39
    buffer_store_dwordx4 v[32:35], v22, s[12:15], s49 offen sc1
    s_add_u32 s49, s49, 266240
    ds_read_u16 v48, v21 offset:192
    ds_read_u16_d16_hi v52, v21 offset:21184
    ds_read_u16 v49, v21 offset:5440
    ds_read_u16_d16_hi v53, v21 offset:26432
    ds_read_u16 v50, v21 offset:10688
    ds_read_u16_d16_hi v54, v21 offset:31680
    ds_read_u16 v51, v21 offset:15936
    s_waitcnt lgkmcnt(14)
    ds_read_u16_d16_hi v55, v21 offset:36928
    s_waitcnt lgkmcnt(8)
    v_or_b32 v40, v40, v44
    v_or_b32 v41, v41, v45
    v_or_b32 v42, v42, v46
    v_or_b32 v43, v43, v47
    buffer_store_dwordx4 v[40:43], v22, s[12:15], s49 offen sc1
    s_add_u32 s49, s49, 266240
    ds_read_u16 v24, v21 offset:256
    ds_read_u16_d16_hi v28, v21 offset:21248
    ds_read_u16 v25, v21 offset:5504
    ds_read_u16_d16_hi v29, v21 offset:26496
    ds_read_u16 v26, v21 offset:10752
    ds_read_u16_d16_hi v30, v21 offset:31744
    ds_read_u16 v27, v21 offset:16000
    s_waitcnt lgkmcnt(14)
    ds_read_u16_d16_hi v31, v21 offset:36992
    s_waitcnt lgkmcnt(8)
    v_or_b32 v48, v48, v52
    v_or_b32 v49, v49, v53
    v_or_b32 v50, v50, v54
    v_or_b32 v51, v51, v55
    buffer_store_dwordx4 v[48:51], v22, s[12:15], s49 offen sc1
    s_add_u32 s49, s49, 266240
    ds_read_u16 v32, v21 offset:320
    ds_read_u16_d16_hi v36, v21 offset:21312
    ds_read_u16 v33, v21 offset:5568
    ds_read_u16_d16_hi v37, v21 offset:26560
    ds_read_u16 v34, v21 offset:10816
    ds_read_u16_d16_hi v38, v21 offset:31808
    ds_read_u16 v35, v21 offset:16064
    s_waitcnt lgkmcnt(14)
    ds_read_u16_d16_hi v39, v21 offset:37056
    s_waitcnt lgkmcnt(8)
    v_or_b32 v24, v24, v28
    v_or_b32 v25, v25, v29
    v_or_b32 v26, v26, v30
    v_or_b32 v27, v27, v31
    buffer_store_dwordx4 v[24:27], v22, s[12:15], s49 offen sc1
    s_add_u32 s49, s49, 266240
    ds_read_u16 v40, v21 offset:384
    ds_read_u16_d16_hi v44, v21 offset:21376
    ds_read_u16 v41, v21 offset:5632
    ds_read_u16_d16_hi v45, v21 offset:26624
    ds_read_u16 v42, v21 offset:10880
    ds_read_u16_d16_hi v46, v21 offset:31872
    ds_read_u16 v43, v21 offset:16128
    s_waitcnt lgkmcnt(14)
    ds_read_u16_d16_hi v47, v21 offset:37120
    s_waitcnt lgkmcnt(8)
    v_or_b32 v32, v32, v36
    v_or_b32 v33, v33, v37
    v_or_b32 v34, v34, v38
    v_or_b32 v35, v35, v39
    buffer_store_dwordx4 v[32:35], v22, s[12:15], s49 offen sc1
    s_add_u32 s49, s49, 266240
    ds_read_u16 v48, v21 offset:448
    ds_read_u16_d16_hi v52, v21 offset:21440
    ds_read_u16 v49, v21 offset:5696
    ds_read_u16_d16_hi v53, v21 offset:26688
    ds_read_u16 v50, v21 offset:10944
    ds_read_u16_d16_hi v54, v21 offset:31936
    ds_read_u16 v51, v21 offset:16192
    s_waitcnt lgkmcnt(14)
    ds_read_u16_d16_hi v55, v21 offset:37184
    s_waitcnt lgkmcnt(8)
    v_or_b32 v40, v40, v44
    v_or_b32 v41, v41, v45
    v_or_b32 v42, v42, v46
    v_or_b32 v43, v43, v47
    buffer_store_dwordx4 v[40:43], v22, s[12:15], s49 offen sc1
    s_add_u32 s49, s49, 266240
    ds_read_u16 v24, v21 offset:512
    ds_read_u16_d16_hi v28, v21 offset:21504
    ds_read_u16 v25, v21 offset:5760
    ds_read_u16_d16_hi v29, v21 offset:26752
    ds_read_u16 v26, v21 offset:11008
    ds_read_u16_d16_hi v30, v21 offset:32000
    ds_read_u16 v27, v21 offset:16256
    s_waitcnt lgkmcnt(14)
    ds_read_u16_d16_hi v31, v21 offset:37248
    s_waitcnt lgkmcnt(8)
    v_or_b32 v48, v48, v52
    v_or_b32 v49, v49, v53
    v_or_b32 v50, v50, v54
    v_or_b32 v51, v51, v55
    buffer_store_dwordx4 v[48:51], v22, s[12:15], s49 offen sc1
    s_add_u32 s49, s49, 266240
    ds_read_u16 v32, v21 offset:576
    ds_read_u16_d16_hi v36, v21 offset:21568
    ds_read_u16 v33, v21 offset:5824
    ds_read_u16_d16_hi v37, v21 offset:26816
    ds_read_u16 v34, v21 offset:11072
    ds_read_u16_d16_hi v38, v21 offset:32064
    ds_read_u16 v35, v21 offset:16320
    s_waitcnt lgkmcnt(14)
    ds_read_u16_d16_hi v39, v21 offset:37312
    s_waitcnt lgkmcnt(8)
    v_or_b32 v24, v24, v28
    v_or_b32 v25, v25, v29
    v_or_b32 v26, v26, v30
    v_or_b32 v27, v27, v31
    buffer_store_dwordx4 v[24:27], v22, s[12:15], s49 offen sc1
    s_add_u32 s49, s49, 266240
    ds_read_u16 v40, v21 offset:640
    ds_read_u16_d16_hi v44, v21 offset:21632
    ds_read_u16 v41, v21 offset:5888
    ds_read_u16_d16_hi v45, v21 offset:26880
    ds_read_u16 v42, v21 offset:11136
    ds_read_u16_d16_hi v46, v21 offset:32128
    ds_read_u16 v43, v21 offset:16384
    s_waitcnt lgkmcnt(14)
    ds_read_u16_d16_hi v47, v21 offset:37376
    s_waitcnt lgkmcnt(8)
    v_or_b32 v32, v32, v36
    v_or_b32 v33, v33, v37
    v_or_b32 v34, v34, v38
    v_or_b32 v35, v35, v39
    buffer_store_dwordx4 v[32:35], v22, s[12:15], s49 offen sc1
    s_add_u32 s49, s49, 266240
    s_waitcnt lgkmcnt(0)
    s_cmp_lg_u32 s3, 0
    s_cbranch_scc1 L_38
    s_mov_b64 exec, 0xff
    v_or_b32 v40, v40, v44
    v_or_b32 v41, v41, v45
    v_or_b32 v42, v42, v46
    v_or_b32 v43, v43, v47
    buffer_store_dwordx4 v[40:43], v22, s[12:15], s49 offen sc1
    s_add_u32 s49, s49, 266240
    s_mov_b64 exec, -1
L_38:
    buffer_load_dwordx2 v[14:15], off, s[28:31], 0 sc1
    s_call_b64 s[38:39], L_task
    s_lshl_b32 s48, s3, 2
    v_add_u32 v8, s48, v12
    v_mov_b32 v9, 1
    s_mov_b32 s40, 0
    s_branch nonc_41
non_39:
    buffer_load_dwordx2 v[14:15], off, s[28:31], 0 sc1
nonc_41:
    s_waitcnt vmcnt(0)
    v_readfirstlane_b32 s6, v14
    v_readfirstlane_b32 s7, v15
    s_add_u32 s40, s40, 1
    s_cmp_lg_u32 s6, 0
    s_cbranch_scc1 nonx_40
    s_sleep 1
    s_cmp_lt_u32 s40, 400000
    s_cbranch_scc1 non_39
nonx_40:
    ds_write_b32 v8, v9 offset:32
    s_branch L_Ft
L_task:
    v_mul_f32 v8, 0x3a800000, v4
    v_mul_f32 v9, v8, v5
    v_mul_f32 v9, 4.0, v9
    v_fmamk_f32 v240, v8, 0x00000000, v9
    v_fmamk_f32 v241, v8, 0x3f800000, v9
    v_fmamk_f32 v242, v8, 0x40000000, v9
    v_fmamk_f32 v243, v8, 0x40400000, v9
    v_fmamk_f32 v244, v8, 0x41000000, v9
    v_fmamk_f32 v245, v8, 0x41100000, v9
    v_fmamk_f32 v246, v8, 0x41200000, v9
    v_fmamk_f32 v247, v8, 0x41300000, v9
    v_fmamk_f32 v248, v8, 0x41800000, v9
    v_fmamk_f32 v249, v8, 0x41880000, v9
    v_fmamk_f32 v250, v8, 0x41900000, v9
    v_fmamk_f32 v251, v8, 0x41980000, v9
    v_fmamk_f32 v252, v8, 0x41c00000, v9
    v_fmamk_f32 v253, v8, 0x41c80000, v9
    v_fmamk_f32 v254, v8, 0x41d00000, v9
    v_fmamk_f32 v255, v8, 0x41d80000, v9
    v_cos_f32 v224, v240
    v_sin_f32 v240, v240
    v_cos_f32 v225, v241
    v_sin_f32 v241, v241
    v_cos_f32 v226, v242
    v_sin_f32 v242, v242
    v_cos_f32 v227, v243
    v_sin_f32 v243, v243
    v_cos_f32 v228, v244
    v_sin_f32 v244, v244
    v_cos_f32 v229, v245
    v_sin_f32 v245, v245
    v_cos_f32 v230, v246
    v_sin_f32 v246, v246
    v_cos_f32 v231, v247
    v_sin_f32 v247, v247
    v_cos_f32 v232, v248
    v_sin_f32 v248, v248
    v_cos_f32 v233, v249
    v_sin_f32 v249, v249
    v_cos_f32 v234, v250
    v_sin_f32 v250, v250
    v_cos_f32 v235, v251
    v_sin_f32 v251, v251
    v_cos_f32 v236, v252
    v_sin_f32 v252, v252
    v_cos_f32 v237, v253
    v_sin_f32 v253, v253
    v_cos_f32 v238, v254
    v_sin_f32 v254, v254
    v_cos_f32 v239, v255
    v_sin_f32 v255, v255
    s_min_u32 s55, s3, 4
    s_cmp_eq_u32 s3, 6
    s_cselect_b32 s55, 5, s55
    s_mul_i32 s52, s44, 5
    s_add_u32 s52, s52, s55
    s_lshl_b32 s53, s55, 5
    s_add_u32 s54, s53, 16
    s_mov_b32 s58, 0
    s_cmp_eq_u32 s52, 0
    s_cselect_b32 s54, 0, s54
    s_cselect_b32 s58, 1, s58
    s_cmp_eq_u32 s52, 320
    s_cselect_b32 s58, 1, s58
    v_mul_u32_u24 v8, 192, v1
    v_add_u32 v8, 81920, v8
    v_add_u32 v16, s53, v8
    v_add_u32 v17, s54, v8
    v_lshrrev_b32 v8, 2, v1
    v_and_b32 v9, 3, v1
    v_lshlrev_b32 v9, 4, v9
    v_lshl_add_u32 v19, v8, 7, v9
    s_mul_i32 s55, s55, 8320
    v_add_u32 v19, s55, v19
    v_mul_f32 v8, 0x3a000000, v4
    v_fmamk_f32 v8, v5, 0x3d800000, v8
    v_add_f32 v152, 0x00000000, v8
    v_add_f32 v153, 0x3c800000, v8
    v_add_f32 v154, 0x3d000000, v8
    v_add_f32 v155, 0x3d400000, v8
    v_add_f32 v156, 0x3e000000, v8
    v_add_f32 v157, 0x3e100000, v8
    v_add_f32 v158, 0x3e200000, v8
    v_add_f32 v159, 0x3e300000, v8
    v_add_f32 v160, 0x3e800000, v8
    v_add_f32 v161, 0x3e880000, v8
    v_add_f32 v162, 0x3e900000, v8
    v_add_f32 v163, 0x3e980000, v8
    v_add_f32 v164, 0x3ec00000, v8
    v_add_f32 v165, 0x3ec80000, v8
    v_add_f32 v166, 0x3ed00000, v8
    v_add_f32 v167, 0x3ed80000, v8
    v_sin_f32 v136, v152
    v_cos_f32 v152, v152
    v_sin_f32 v137, v153
    v_cos_f32 v153, v153
    v_sin_f32 v138, v154
    v_cos_f32 v154, v154
    v_sin_f32 v139, v155
    v_cos_f32 v155, v155
    v_sin_f32 v140, v156
    v_cos_f32 v156, v156
    v_sin_f32 v141, v157
    v_cos_f32 v157, v157
    v_sin_f32 v142, v158
    v_cos_f32 v158, v158
    v_sin_f32 v143, v159
    v_cos_f32 v159, v159
    v_sin_f32 v144, v160
    v_cos_f32 v160, v160
    v_sin_f32 v145, v161
    v_cos_f32 v161, v161
    v_sin_f32 v146, v162
    v_cos_f32 v162, v162
    v_sin_f32 v147, v163
    v_cos_f32 v163, v163
    v_sin_f32 v148, v164
    v_cos_f32 v164, v164
    v_sin_f32 v149, v165
    v_cos_f32 v165, v165
    v_sin_f32 v150, v166
    v_cos_f32 v166, v166
    v_sin_f32 v151, v167
    v_cos_f32 v167, v167
    v_cvt_pk_bf16_f32 v88, v136, v152
    v_cvt_pk_bf16_f32 v89, v137, v153
    v_cvt_pk_bf16_f32 v90, v138, v154
    v_cvt_pk_bf16_f32 v91, v139, v155
    v_cvt_pk_bf16_f32 v92, v140, v156
    v_cvt_pk_bf16_f32 v93, v141, v157
    v_cvt_pk_bf16_f32 v94, v142, v158
    v_cvt_pk_bf16_f32 v95, v143, v159
    v_cvt_pk_bf16_f32 v96, v144, v160
    v_cvt_pk_bf16_f32 v97, v145, v161
    v_cvt_pk_bf16_f32 v98, v146, v162
    v_cvt_pk_bf16_f32 v99, v147, v163
    v_cvt_pk_bf16_f32 v100, v148, v164
    v_cvt_pk_bf16_f32 v101, v149, v165
    v_cvt_pk_bf16_f32 v102, v150, v166
    v_cvt_pk_bf16_f32 v103, v151, v167
    s_setpc_b64 s[38:39]
L_Fhi:
    s_lshl_b32 s44, s4, 3
    s_add_u32 s44, s44, s5
    s_sub_u32 s44, s44, 24
    v_lshlrev_b32 v18, 4, v1
    s_cmp_lt_u32 s3, 6
    s_cbranch_scc1 L_43
    s_cmp_lg_u32 s3, 7
    s_cbranch_scc1 L_42
    s_mov_b32 s40, 0
    s_branch nonc_47
non_45:
    buffer_load_dwordx2 v[14:15], off, s[28:31], 0 sc1
nonc_47:
    s_waitcnt vmcnt(0)
    v_readfirstlane_b32 s6, v14
    v_readfirstlane_b32 s7, v15
    s_add_u32 s40, s40, 1
    s_cmp_lg_u32 s6, 0
    s_cbranch_scc1 nonx_46
    s_sleep 1
    s_cmp_lt_u32 s40, 400000
    s_cbranch_scc1 non_45
nonx_46:
    s_lshr_b32 s48, s41, 1
    s_lshl_b32 s48, s48, 8
    s_and_b32 s62, s41, 1
    s_lshl_b32 s62, s62, 6
    s_add_u32 s48, s48, s62
    s_add_u32 s48, s48, 24772608
    v_and_b32 v8, 3, v1
    v_lshlrev_b32 v8, 4, v8
    v_lshrrev_b32 v9, 2, v1
    v_lshl_add_u32 v8, v9, 7, v8
    v_mov_b32 v57, s6
    v_mov_b32 v59, s6
    s_mov_b64 exec, 0xff
    buffer_store_dwordx4 v[56:59], v8, s[12:15], s48 offen sc1
    s_mov_b64 exec, -1
    s_lshl_b32 s48, s4, 3
    s_and_b32 s40, s5, 7
    s_add_u32 s48, s48, s40
    s_lshl_b32 s48, s48, 9
    s_and_b32 s40, s5, 24
    s_lshl_b32 s40, s40, 4
    s_add_u32 s48, s48, s40
    s_add_u32 s48, s48, 16256
    v_lshlrev_b32 v21, 3, v1
    v_add_u32 v21, s48, v21
    s_lshl_b32 s48, s41, 3
    s_mov_b64 exec, 0xff
    v_lshlrev_b32 v21, 11, v1
    v_add_u32 v21, s48, v21
    s_mov_b64 exec, -1
    s_mov_b32 s48, 25001984
    v_mov_b32 v14, s6
    v_mov_b32 v15, s7
    s_mov_b64 exec, 0xffff00ff
    buffer_store_dwordx2 v[14:15], v21, s[12:15], s48 offen offset:0 sc1
    s_mov_b64 exec, -1
    v_lshlrev_b32 v21, 7, v1
    s_lshl_b32 s53, s44, 9
    s_add_u32 s53, s53, 25018368
    s_mov_b64 exec, 7
    s_mov_b32 s40, 0
poll_48:
    buffer_load_dwordx2 v[24:25], v21, s[12:15], s53 offen offset:0 sc1
pollc_50:
    s_waitcnt vmcnt(0)
    v_cmp_ne_u64 vcc, s[6:7], v[24:25]
    s_add_u32 s40, s40, 1
    s_cbranch_vccz pollx_49
    s_sleep 12
    s_cmp_lt_u32 s40, 400000
    s_cbranch_scc1 poll_48
pollx_49:
    s_mov_b64 exec, -1
    s_lshl_b32 s48, s4, 11
    s_add_u32 s48, s48, 25001984
    s_mov_b32 s40, 0
pollx1_51:
    buffer_load_dwordx4 v[24:27], v18, s[12:15], s48 offen sc1
    buffer_load_dwordx4 v[28:31], v18, s[12:15], s48 offen offset:1024 sc1
    s_waitcnt vmcnt(0)
    v_cmp_ne_u64 vcc, s[6:7], v[24:25]
    v_cmp_ne_u64 s[56:57], s[6:7], v[26:27]
    s_nop 0
    s_or_b64 vcc, vcc, s[56:57]
    v_cmp_ne_u64 s[56:57], s[6:7], v[28:29]
    s_nop 0
    s_or_b64 vcc, vcc, s[56:57]
    v_cmp_ne_u64 s[56:57], s[6:7], v[30:31]
    s_nop 0
    s_or_b64 vcc, vcc, s[56:57]
    s_add_u32 s40, s40, 1
    s_cbranch_vccz L_52
    s_sleep 6
    s_cmp_lt_u32 s40, 400000
    s_cbranch_scc1 pollx1_51
L_52:
    s_mul_i32 s48, s44, 49536
    s_add_u32 s49, s48, 49152
    s_mov_b32 m0, 81920
    s_mov_b32 s59, 131136
    s_branch L_44
L_42:
    s_cmp_lg_u32 s44, 63
    s_cbranch_scc1 L_53
    s_call_b64 s[38:39], L_task
L_53:
    s_mov_b32 s40, 0
non_54:
    buffer_load_dwordx2 v[14:15], off, s[28:31], 0 sc1
nonc_56:
    s_waitcnt vmcnt(0)
    v_readfirstlane_b32 s6, v14
    v_readfirstlane_b32 s7, v15
    s_add_u32 s40, s40, 1
    s_cmp_lg_u32 s6, 0
    s_cbranch_scc1 nonx_55
    s_sleep 1
    s_cmp_lt_u32 s40, 400000
    s_cbranch_scc1 non_54
nonx_55:
    s_mov_b32 s40, 0
lw_57:
    ds_read_b128 v[24:27], v20 offset:32
    s_add_u32 s40, s40, 1
    s_waitcnt lgkmcnt(0)
    v_min3_u32 v24, v24, v25, v26
    v_min_u32 v24, v24, v27
    v_cmp_gt_u32 vcc, 1, v24
    s_cbranch_vccz lwx_58
    s_sleep 2
    s_cmp_lt_u32 s40, 3200000
    s_cbranch_scc1 lw_57
lwx_58:
    s_lshl_b32 s48, s44, 3
    v_lshlrev_b32 v21, 9, v1
    v_add_u32 v21, s48, v21
    s_mov_b32 s48, 25051136
    v_mov_b32 v14, s6
    v_mov_b32 v15, s7
    s_mov_b64 exec, -1
    buffer_store_dwordx2 v[14:15], v21, s[12:15], s48 offen offset:0 sc1
    s_mov_b64 exec, -1
    v_lshlrev_b32 v21, 3, v1
    s_lshl_b32 s48, s44, 9
    s_add_u32 s48, s48, 25051136
    s_mov_b32 s40, 0
poll_59:
    buffer_load_dwordx2 v[24:25], v21, s[12:15], s48 offen offset:0 sc1
pollc_61:
    s_waitcnt vmcnt(0)
    v_cmp_ne_u64 vcc, s[6:7], v[24:25]
    s_add_u32 s40, s40, 1
    s_cbranch_vccz pollx_60
    s_sleep 6
    s_cmp_lt_u32 s40, 400000
    s_cbranch_scc1 poll_59
pollx_60:
    s_mul_i32 s48, s44, 41600
    s_add_u32 s48, s48, 3170304
    s_cmp_eq_u32 s44, 63
    s_cselect_b32 s49, 6, 5
    s_mul_i32 s49, s49, 8320
    s_add_u32 s49, s49, s48
    s_mov_b32 m0, 0
    s_mov_b32 s59, 131152
L_44:
L_62:
    buffer_load_dwordx4 v18, s[12:15], s48 offen offset:0 sc1 lds
    buffer_load_dwordx4 v18, s[12:15], s48 offen offset:1024 sc1 lds
    buffer_load_dwordx4 v18, s[12:15], s48 offen offset:2048 sc1 lds
    buffer_load_dwordx4 v18, s[12:15], s48 offen offset:3072 sc1 lds
    s_add_u32 m0, m0, 4096
    s_add_u32 s48, s48, 4096
    s_cmp_lt_u32 s48, s49
    s_cbranch_scc1 L_62
    v_mov_b32 v8, s59
    v_mov_b32 v24, 1
    v_mov_b32 v25, 1
    v_mov_b32 v26, 1
    v_mov_b32 v27, 1
    s_waitcnt vmcnt(0)
    ds_write_b128 v8, v[24:27]
    s_setprio 0
    s_cmp_lg_u32 s3, 6
    s_cbranch_scc1 L_idle
    s_cmp_lg_u32 s44, 63
    s_cbranch_scc1 L_idle
    s_branch L_Ft
L_43:
    s_setprio 0
    s_call_b64 s[38:39], L_task
    s_and_b32 s49, s3, 1
    s_lshl_b32 s57, s49, 31
    s_lshl_b32 s50, s49, 15
    s_or_b32 s51, s57, s50
    s_mov_b32 s56, 0xffff0000
    v_xor_b32 v88, s51, v88
    v_xor_b32 v89, s51, v89
    v_xor_b32 v90, s51, v90
    v_xor_b32 v91, s51, v91
    v_xor_b32 v92, s51, v92
    v_xor_b32 v93, s51, v93
    v_xor_b32 v94, s51, v94
    v_xor_b32 v95, s51, v95
    v_xor_b32 v96, s51, v96
    v_xor_b32 v97, s51, v97
    v_xor_b32 v98, s51, v98
    v_xor_b32 v99, s51, v99
    v_xor_b32 v100, s51, v100
    v_xor_b32 v101, s51, v101
    v_xor_b32 v102, s51, v102
    v_xor_b32 v103, s51, v103
    s_lshl_b32 s48, s49, 4
    v_add_u32 v16, s48, v16
    v_add_u32 v10, s48, v20
    v_sub_u32 v11, v20, v10
    v_add_u32 v11, v11, v20
    s_lshl_b32 s48, s49, 13
    s_add_u32 s48, s48, 65536
    v_add_u32 v21, s48, v18
    v_xor_b32 v17, 8192, v21
    s_mul_i32 s53, s52, 8448
    s_mul_i32 s48, s49, 4224
    s_add_u32 s53, s53, s48
    s_add_u32 s53, s53, 6340608
    s_mov_b32 s40, 0
lw_63:
    ds_read_b128 v[24:27], v20 offset:64
    s_add_u32 s40, s40, 1
    s_waitcnt lgkmcnt(0)
    v_min3_u32 v24, v24, v25, v26
    v_min_u32 v24, v24, v27
    v_cmp_gt_u32 vcc, 1, v24
    s_cbranch_vccz lwx_64
    s_sleep 1
    s_cmp_lt_u32 s40, 3200000
    s_cbranch_scc1 lw_63
lwx_64:
    ds_read_b128 v[24:27], v16 offset:0
    ds_read_b128 v[28:31], v16 offset:12288
    ds_read_b128 v[32:35], v16 offset:24576
    ds_read_b128 v[36:39], v16 offset:36864
    s_waitcnt lgkmcnt(0)
    v_xor_b32 v24, s57, v24
    v_xor_b32 v25, s57, v25
    v_xor_b32 v26, s57, v26
    v_xor_b32 v27, s57, v27
    v_xor_b32 v28, s57, v28
    v_xor_b32 v29, s57, v29
    v_xor_b32 v30, s57, v30
    v_xor_b32 v31, s57, v31
    v_xor_b32 v32, s57, v32
    v_xor_b32 v33, s57, v33
    v_xor_b32 v34, s57, v34
    v_xor_b32 v35, s57, v35
    v_xor_b32 v36, s57, v36
    v_xor_b32 v37, s57, v37
    v_xor_b32 v38, s57, v38
    v_xor_b32 v39, s57, v39
    v_mfma_f32_32x32x16_bf16 v[104:119], v[24:27], v[192:195], 0
    v_mfma_f32_32x32x16_bf16 v[120:135], v[24:27], v[208:211], 0
    v_mfma_f32_32x32x16_bf16 v[104:119], v[28:31], v[196:199], v[104:119]
    v_mfma_f32_32x32x16_bf16 v[120:135], v[28:31], v[212:215], v[120:135]
    v_mfma_f32_32x32x16_bf16 v[104:119], v[32:35], v[200:203], v[104:119]
    v_mfma_f32_32x32x16_bf16 v[120:135], v[32:35], v[216:219], v[120:135]
    v_mfma_f32_32x32x16_bf16 v[104:119], v[36:39], v[204:207], v[104:119]
    v_mfma_f32_32x32x16_bf16 v[120:135], v[36:39], v[220:223], v[120:135]
    s_nop 10
    v_pk_mul_f32 v[168:169], v[104:105], v[224:225]
    v_pk_mul_f32 v[170:171], v[120:121], v[224:225]
    v_pk_mul_f32 v[172:173], v[106:107], v[226:227]
    v_pk_mul_f32 v[174:175], v[122:123], v[226:227]
    v_pk_fma_f32 v[168:169], v[120:121], v[240:241], v[168:169]
    v_pk_fma_f32 v[170:171], v[104:105], v[240:241], v[170:171] neg_lo:[1,0,0] neg_hi:[1,0,0]
    v_pk_fma_f32 v[172:173], v[122:123], v[242:243], v[172:173]
    v_pk_fma_f32 v[174:175], v[106:107], v[242:243], v[174:175] neg_lo:[1,0,0] neg_hi:[1,0,0]
    v_cvt_pk_bf16_f32 v24, v168, v170
    v_cvt_pk_bf16_f32 v25, v169, v171
    v_cvt_pk_bf16_f32 v26, v172, v174
    v_cvt_pk_bf16_f32 v27, v173, v175
    v_pk_mul_f32 v[168:169], v[108:109], v[228:229]
    v_pk_mul_f32 v[170:171], v[124:125], v[228:229]
    v_pk_mul_f32 v[172:173], v[110:111], v[230:231]
    v_pk_mul_f32 v[174:175], v[126:127], v[230:231]
    v_pk_fma_f32 v[168:169], v[124:125], v[244:245], v[168:169]
    v_pk_fma_f32 v[170:171], v[108:109], v[244:245], v[170:171] neg_lo:[1,0,0] neg_hi:[1,0,0]
    v_pk_fma_f32 v[172:173], v[126:127], v[246:247], v[172:173]
    v_pk_fma_f32 v[174:175], v[110:111], v[246:247], v[174:175] neg_lo:[1,0,0] neg_hi:[1,0,0]
    v_cvt_pk_bf16_f32 v28, v168, v170
    v_cvt_pk_bf16_f32 v29, v169, v171
    v_cvt_pk_bf16_f32 v30, v172, v174
    v_cvt_pk_bf16_f32 v31, v173, v175
    v_pk_mul_f32 v[168:169], v[112:113], v[232:233]
    v_pk_mul_f32 v[170:171], v[128:129], v[232:233]
    v_pk_mul_f32 v[172:173], v[114:115], v[234:235]
    v_pk_mul_f32 v[174:175], v[130:131], v[234:235]
    v_pk_fma_f32 v[168:169], v[128:129], v[248:249], v[168:169]
    v_pk_fma_f32 v[170:171], v[112:113], v[248:249], v[170:171] neg_lo:[1,0,0] neg_hi:[1,0,0]
    v_pk_fma_f32 v[172:173], v[130:131], v[250:251], v[172:173]
    v_pk_fma_f32 v[174:175], v[114:115], v[250:251], v[174:175] neg_lo:[1,0,0] neg_hi:[1,0,0]
    v_cvt_pk_bf16_f32 v32, v168, v170
    v_cvt_pk_bf16_f32 v33, v169, v171
    v_cvt_pk_bf16_f32 v34, v172, v174
    v_cvt_pk_bf16_f32 v35, v173, v175
    v_pk_mul_f32 v[168:169], v[116:117], v[236:237]
    v_pk_mul_f32 v[170:171], v[132:133], v[236:237]
    v_pk_mul_f32 v[172:173], v[118:119], v[238:239]
    v_pk_mul_f32 v[174:175], v[134:135], v[238:239]
    v_pk_fma_f32 v[168:169], v[132:133], v[252:253], v[168:169]
    v_pk_fma_f32 v[170:171], v[116:117], v[252:253], v[170:171] neg_lo:[1,0,0] neg_hi:[1,0,0]
    v_pk_fma_f32 v[172:173], v[134:135], v[254:255], v[172:173]
    v_pk_fma_f32 v[174:175], v[118:119], v[254:255], v[174:175] neg_lo:[1,0,0] neg_hi:[1,0,0]
    v_cvt_pk_bf16_f32 v36, v168, v170
    v_cvt_pk_bf16_f32 v37, v169, v171
    v_cvt_pk_bf16_f32 v38, v172, v174
    v_cvt_pk_bf16_f32 v39, v173, v175
    v_mfma_f32_32x32x16_bf16 v[104:119], v[192:195], v[24:27], 0
    v_mfma_f32_32x32x16_bf16 v[120:135], v[208:211], v[24:27], 0
    v_mfma_f32_32x32x16_bf16 v[104:119], v[196:199], v[28:31], v[104:119]
    v_mfma_f32_32x32x16_bf16 v[120:135], v[212:215], v[28:31], v[120:135]
    v_mfma_f32_32x32x16_bf16 v[104:119], v[200:203], v[32:35], v[104:119]
    v_mfma_f32_32x32x16_bf16 v[120:135], v[216:219], v[32:35], v[120:135]
    v_mfma_f32_32x32x16_bf16 v[104:119], v[204:207], v[36:39], v[104:119]
    v_mfma_f32_32x32x16_bf16 v[120:135], v[220:223], v[36:39], v[120:135]
    v_mov_b32 v24, 1
    v_mov_b32 v25, 1
    v_mov_b32 v26, 1
    v_mov_b32 v27, 1
    s_nop 6
    ds_write_b128 v21, v[104:107] offset:0
    ds_write_b128 v21, v[108:111] offset:1024
    ds_write_b128 v21, v[112:115] offset:2048
    ds_write_b128 v21, v[116:119] offset:3072
    ds_write_b128 v21, v[120:123] offset:4096
    ds_write_b128 v21, v[124:127] offset:5120
    ds_write_b128 v21, v[128:131] offset:6144
    ds_write_b128 v21, v[132:135] offset:7168
    ds_write_b128 v10, v[24:27] offset:112
    s_mov_b32 s40, 0
lw_65:
    ds_read_b128 v[168:171], v20 offset:80
    s_add_u32 s40, s40, 1
    s_waitcnt lgkmcnt(0)
    v_min3_u32 v168, v168, v169, v170
    v_min_u32 v168, v168, v171
    v_cmp_gt_u32 vcc, 1, v168
    s_cbranch_vccz lwx_66
    s_sleep 1
    s_cmp_lt_u32 s40, 3200000
    s_cbranch_scc1 lw_65
lwx_66:
    ds_read_b128 v[56:59], v19 offset:0
    ds_read_b128 v[72:75], v19 offset:64
    ds_read_b128 v[60:63], v19 offset:2048
    ds_read_b128 v[76:79], v19 offset:2112
    ds_read_b128 v[64:67], v19 offset:4096
    ds_read_b128 v[80:83], v19 offset:4160
    ds_read_b128 v[68:71], v19 offset:6144
    ds_read_b128 v[84:87], v19 offset:6208
    s_mov_b32 s40, 0
lw_67:
    ds_read_b128 v[168:171], v11 offset:128
    s_add_u32 s40, s40, 1
    s_waitcnt lgkmcnt(0)
    v_min3_u32 v168, v168, v169, v170
    v_min_u32 v168, v168, v171
    v_cmp_gt_u32 vcc, 1, v168
    s_cbranch_vccz lwx_68
    s_cmp_lt_u32 s40, 3200000
    s_cbranch_scc1 lw_67
lwx_68:
    ds_read_b128 v[136:139], v17 offset:0
    ds_read_b128 v[140:143], v17 offset:1024
    ds_read_b128 v[144:147], v17 offset:2048
    ds_read_b128 v[148:151], v17 offset:3072
    ds_read_b128 v[152:155], v17 offset:4096
    ds_read_b128 v[156:159], v17 offset:5120
    ds_read_b128 v[160:163], v17 offset:6144
    ds_read_b128 v[164:167], v17 offset:7168
    v_lshlrev_b32 v172, 16, v56
    v_and_b32 v174, s56, v56
    v_lshlrev_b32 v173, 16, v57
    v_and_b32 v175, s56, v57
    v_lshlrev_b32 v176, 16, v72
    v_and_b32 v178, s56, v72
    v_lshlrev_b32 v177, 16, v73
    v_and_b32 v179, s56, v73
    v_lshlrev_b32 v180, 16, v88
    v_and_b32 v182, s56, v88
    v_lshlrev_b32 v181, 16, v89
    v_and_b32 v183, s56, v89
    v_pk_add_f32 v[168:169], v[172:173], v[176:177]
    v_pk_add_f32 v[170:171], v[174:175], v[178:179]
    v_pk_add_f32 v[172:173], v[172:173], v[176:177] neg_lo:[0,1] neg_hi:[0,1]
    v_pk_add_f32 v[174:175], v[174:175], v[178:179] neg_lo:[0,1] neg_hi:[0,1]
    v_pk_fma_f32 v[168:169], v[180:181], v[172:173], v[168:169] neg_lo:[1,0,0] neg_hi:[1,0,0]
    v_pk_fma_f32 v[170:171], v[180:181], v[174:175], v[170:171] neg_lo:[1,0,0] neg_hi:[1,0,0]
    v_pk_mul_f32 v[172:173], v[182:183], v[172:173]
    v_pk_mul_f32 v[174:175], v[182:183], v[174:175]
    s_waitcnt lgkmcnt(0)
    v_pk_mul_f32 v[176:177], v[168:169], v[104:105]
    v_pk_mul_f32 v[178:179], v[168:169], v[120:121]
    v_pk_fma_f32 v[176:177], v[170:171], v[120:121], v[176:177] neg_lo:[1,0,0] neg_hi:[1,0,0]
    v_pk_fma_f32 v[178:179], v[170:171], v[104:105], v[178:179]
    v_pk_fma_f32 v[176:177], v[174:175], v[136:137], v[176:177] neg_lo:[1,0,0] neg_hi:[1,0,0]
    v_pk_fma_f32 v[178:179], v[172:173], v[136:137], v[178:179]
    v_pk_fma_f32 v[176:177], v[172:173], v[152:153], v[176:177] neg_lo:[1,0,0] neg_hi:[1,0,0]
    v_pk_fma_f32 v[178:179], v[174:175], v[152:153], v[178:179] neg_lo:[1,0,0] neg_hi:[1,0,0]
    v_cvt_pk_bf16_f32 v24, v178, v176
    v_cvt_pk_bf16_f32 v25, v179, v177
    v_lshlrev_b32 v172, 16, v58
    v_and_b32 v174, s56, v58
    v_lshlrev_b32 v173, 16, v59
    v_and_b32 v175, s56, v59
    v_lshlrev_b32 v176, 16, v74
    v_and_b32 v178, s56, v74
    v_lshlrev_b32 v177, 16, v75
    v_and_b32 v179, s56, v75
    v_lshlrev_b32 v180, 16, v90
    v_and_b32 v182, s56, v90
    v_lshlrev_b32 v181, 16, v91
    v_and_b32 v183, s56, v91
    v_pk_add_f32 v[168:169], v[172:173], v[176:177]
    v_pk_add_f32 v[170:171], v[174:175], v[178:179]
    v_pk_add_f32 v[172:173], v[172:173], v[176:177] neg_lo:[0,1] neg_hi:[0,1]
    v_pk_add_f32 v[174:175], v[174:175], v[178:179] neg_lo:[0,1] neg_hi:[0,1]
    v_pk_fma_f32 v[168:169], v[180:181], v[172:173], v[168:169] neg_lo:[1,0,0] neg_hi:[1,0,0]
    v_pk_fma_f32 v[170:171], v[180:181], v[174:175], v[170:171] neg_lo:[1,0,0] neg_hi:[1,0,0]
    v_pk_mul_f32 v[172:173], v[182:183], v[172:173]
    v_pk_mul_f32 v[174:175], v[182:183], v[174:175]
    v_pk_mul_f32 v[176:177], v[168:169], v[106:107]
    v_pk_mul_f32 v[178:179], v[168:169], v[122:123]
    v_pk_fma_f32 v[176:177], v[170:171], v[122:123], v[176:177] neg_lo:[1,0,0] neg_hi:[1,0,0]
    v_pk_fma_f32 v[178:179], v[170:171], v[106:107], v[178:179]
    v_pk_fma_f32 v[176:177], v[174:175], v[138:139], v[176:177] neg_lo:[1,0,0] neg_hi:[1,0,0]
    v_pk_fma_f32 v[178:179], v[172:173], v[138:139], v[178:179]
    v_pk_fma_f32 v[176:177], v[172:173], v[154:155], v[176:177] neg_lo:[1,0,0] neg_hi:[1,0,0]
    v_pk_fma_f32 v[178:179], v[174:175], v[154:155], v[178:179] neg_lo:[1,0,0] neg_hi:[1,0,0]
    v_cvt_pk_bf16_f32 v26, v178, v176
    v_cvt_pk_bf16_f32 v27, v179, v177
    v_lshlrev_b32 v172, 16, v60
    v_and_b32 v174, s56, v60
    v_lshlrev_b32 v173, 16, v61
    v_and_b32 v175, s56, v61
    v_lshlrev_b32 v176, 16, v76
    v_and_b32 v178, s56, v76
    v_lshlrev_b32 v177, 16, v77
    v_and_b32 v179, s56, v77
    v_lshlrev_b32 v180, 16, v92
    v_and_b32 v182, s56, v92
    v_lshlrev_b32 v181, 16, v93
    v_and_b32 v183, s56, v93
    v_pk_add_f32 v[168:169], v[172:173], v[176:177]
    v_pk_add_f32 v[170:171], v[174:175], v[178:179]
    v_pk_add_f32 v[172:173], v[172:173], v[176:177] neg_lo:[0,1] neg_hi:[0,1]
    v_pk_add_f32 v[174:175], v[174:175], v[178:179] neg_lo:[0,1] neg_hi:[0,1]
    v_pk_fma_f32 v[168:169], v[180:181], v[172:173], v[168:169] neg_lo:[1,0,0] neg_hi:[1,0,0]
    v_pk_fma_f32 v[170:171], v[180:181], v[174:175], v[170:171] neg_lo:[1,0,0] neg_hi:[1,0,0]
    v_pk_mul_f32 v[172:173], v[182:183], v[172:173]
    v_pk_mul_f32 v[174:175], v[182:183], v[174:175]
    v_pk_mul_f32 v[176:177], v[168:169], v[108:109]
    v_pk_mul_f32 v[178:179], v[168:169], v[124:125]
    v_pk_fma_f32 v[176:177], v[170:171], v[124:125], v[176:177] neg_lo:[1,0,0] neg_hi:[1,0,0]
    v_pk_fma_f32 v[178:179], v[170:171], v[108:109], v[178:179]
    v_pk_fma_f32 v[176:177], v[174:175], v[140:141], v[176:177] neg_lo:[1,0,0] neg_hi:[1,0,0]
    v_pk_fma_f32 v[178:179], v[172:173], v[140:141], v[178:179]
    v_pk_fma_f32 v[176:177], v[172:173], v[156:157], v[176:177] neg_lo:[1,0,0] neg_hi:[1,0,0]
    v_pk_fma_f32 v[178:179], v[174:175], v[156:157], v[178:179] neg_lo:[1,0,0] neg_hi:[1,0,0]
    v_cvt_pk_bf16_f32 v28, v178, v176
    v_cvt_pk_bf16_f32 v29, v179, v177
    v_lshlrev_b32 v172, 16, v62
    v_and_b32 v174, s56, v62
    v_lshlrev_b32 v173, 16, v63
    v_and_b32 v175, s56, v63
    v_lshlrev_b32 v176, 16, v78
    v_and_b32 v178, s56, v78
    v_lshlrev_b32 v177, 16, v79
    v_and_b32 v179, s56, v79
    v_lshlrev_b32 v180, 16, v94
    v_and_b32 v182, s56, v94
    v_lshlrev_b32 v181, 16, v95
    v_and_b32 v183, s56, v95
    v_pk_add_f32 v[168:169], v[172:173], v[176:177]
    v_pk_add_f32 v[170:171], v[174:175], v[178:179]
    v_pk_add_f32 v[172:173], v[172:173], v[176:177] neg_lo:[0,1] neg_hi:[0,1]
    v_pk_add_f32 v[174:175], v[174:175], v[178:179] neg_lo:[0,1] neg_hi:[0,1]
    v_pk_fma_f32 v[168:169], v[180:181], v[172:173], v[168:169] neg_lo:[1,0,0] neg_hi:[1,0,0]
    v_pk_fma_f32 v[170:171], v[180:181], v[174:175], v[170:171] neg_lo:[1,0,0] neg_hi:[1,0,0]
    v_pk_mul_f32 v[172:173], v[182:183], v[172:173]
    v_pk_mul_f32 v[174:175], v[182:183], v[174:175]
    v_pk_mul_f32 v[176:177], v[168:169], v[110:111]
    v_pk_mul_f32 v[178:179], v[168:169], v[126:127]
    v_pk_fma_f32 v[176:177], v[170:171], v[126:127], v[176:177] neg_lo:[1,0,0] neg_hi:[1,0,0]
    v_pk_fma_f32 v[178:179], v[170:171], v[110:111], v[178:179]
    v_pk_fma_f32 v[176:177], v[174:175], v[142:143], v[176:177] neg_lo:[1,0,0] neg_hi:[1,0,0]
    v_pk_fma_f32 v[178:179], v[172:173], v[142:143], v[178:179]
    v_pk_fma_f32 v[176:177], v[172:173], v[158:159], v[176:177] neg_lo:[1,0,0] neg_hi:[1,0,0]
    v_pk_fma_f32 v[178:179], v[174:175], v[158:159], v[178:179] neg_lo:[1,0,0] neg_hi:[1,0,0]
    v_cvt_pk_bf16_f32 v30, v178, v176
    v_cvt_pk_bf16_f32 v31, v179, v177
    v_lshlrev_b32 v172, 16, v64
    v_and_b32 v174, s56, v64
    v_lshlrev_b32 v173, 16, v65
    v_and_b32 v175, s56, v65
    v_lshlrev_b32 v176, 16, v80
    v_and_b32 v178, s56, v80
    v_lshlrev_b32 v177, 16, v81
    v_and_b32 v179, s56, v81
    v_lshlrev_b32 v180, 16, v96
    v_and_b32 v182, s56, v96
    v_lshlrev_b32 v181, 16, v97
    v_and_b32 v183, s56, v97
    v_pk_add_f32 v[168:169], v[172:173], v[176:177]
    v_pk_add_f32 v[170:171], v[174:175], v[178:179]
    v_pk_add_f32 v[172:173], v[172:173], v[176:177] neg_lo:[0,1] neg_hi:[0,1]
    v_pk_add_f32 v[174:175], v[174:175], v[178:179] neg_lo:[0,1] neg_hi:[0,1]
    v_pk_fma_f32 v[168:169], v[180:181], v[172:173], v[168:169] neg_lo:[1,0,0] neg_hi:[1,0,0]
    v_pk_fma_f32 v[170:171], v[180:181], v[174:175], v[170:171] neg_lo:[1,0,0] neg_hi:[1,0,0]
    v_pk_mul_f32 v[172:173], v[182:183], v[172:173]
    v_pk_mul_f32 v[174:175], v[182:183], v[174:175]
    v_pk_mul_f32 v[176:177], v[168:169], v[112:113]
    v_pk_mul_f32 v[178:179], v[168:169], v[128:129]
    v_pk_fma_f32 v[176:177], v[170:171], v[128:129], v[176:177] neg_lo:[1,0,0] neg_hi:[1,0,0]
    v_pk_fma_f32 v[178:179], v[170:171], v[112:113], v[178:179]
    v_pk_fma_f32 v[176:177], v[174:175], v[144:145], v[176:177] neg_lo:[1,0,0] neg_hi:[1,0,0]
    v_pk_fma_f32 v[178:179], v[172:173], v[144:145], v[178:179]
    v_pk_fma_f32 v[176:177], v[172:173], v[160:161], v[176:177] neg_lo:[1,0,0] neg_hi:[1,0,0]
    v_pk_fma_f32 v[178:179], v[174:175], v[160:161], v[178:179] neg_lo:[1,0,0] neg_hi:[1,0,0]
    v_cvt_pk_bf16_f32 v32, v178, v176
    v_cvt_pk_bf16_f32 v33, v179, v177
    v_lshlrev_b32 v172, 16, v66
    v_and_b32 v174, s56, v66
    v_lshlrev_b32 v173, 16, v67
    v_and_b32 v175, s56, v67
    v_lshlrev_b32 v176, 16, v82
    v_and_b32 v178, s56, v82
    v_lshlrev_b32 v177, 16, v83
    v_and_b32 v179, s56, v83
    v_lshlrev_b32 v180, 16, v98
    v_and_b32 v182, s56, v98
    v_lshlrev_b32 v181, 16, v99
    v_and_b32 v183, s56, v99
    v_pk_add_f32 v[168:169], v[172:173], v[176:177]
    v_pk_add_f32 v[170:171], v[174:175], v[178:179]
    v_pk_add_f32 v[172:173], v[172:173], v[176:177] neg_lo:[0,1] neg_hi:[0,1]
    v_pk_add_f32 v[174:175], v[174:175], v[178:179] neg_lo:[0,1] neg_hi:[0,1]
    v_pk_fma_f32 v[168:169], v[180:181], v[172:173], v[168:169] neg_lo:[1,0,0] neg_hi:[1,0,0]
    v_pk_fma_f32 v[170:171], v[180:181], v[174:175], v[170:171] neg_lo:[1,0,0] neg_hi:[1,0,0]
    v_pk_mul_f32 v[172:173], v[182:183], v[172:173]
    v_pk_mul_f32 v[174:175], v[182:183], v[174:175]
    v_pk_mul_f32 v[176:177], v[168:169], v[114:115]
    v_pk_mul_f32 v[178:179], v[168:169], v[130:131]
    v_pk_fma_f32 v[176:177], v[170:171], v[130:131], v[176:177] neg_lo:[1,0,0] neg_hi:[1,0,0]
    v_pk_fma_f32 v[178:179], v[170:171], v[114:115], v[178:179]
    v_pk_fma_f32 v[176:177], v[174:175], v[146:147], v[176:177] neg_lo:[1,0,0] neg_hi:[1,0,0]
    v_pk_fma_f32 v[178:179], v[172:173], v[146:147], v[178:179]
    v_pk_fma_f32 v[176:177], v[172:173], v[162:163], v[176:177] neg_lo:[1,0,0] neg_hi:[1,0,0]
    v_pk_fma_f32 v[178:179], v[174:175], v[162:163], v[178:179] neg_lo:[1,0,0] neg_hi:[1,0,0]
    v_cvt_pk_bf16_f32 v34, v178, v176
    v_cvt_pk_bf16_f32 v35, v179, v177
    v_lshlrev_b32 v172, 16, v68
    v_and_b32 v174, s56, v68
    v_lshlrev_b32 v173, 16, v69
    v_and_b32 v175, s56, v69
    v_lshlrev_b32 v176, 16, v84
    v_and_b32 v178, s56, v84
    v_lshlrev_b32 v177, 16, v85
    v_and_b32 v179, s56, v85
    v_lshlrev_b32 v180, 16, v100
    v_and_b32 v182, s56, v100
    v_lshlrev_b32 v181, 16, v101
    v_and_b32 v183, s56, v101
    v_pk_add_f32 v[168:169], v[172:173], v[176:177]
    v_pk_add_f32 v[170:171], v[174:175], v[178:179]
    v_pk_add_f32 v[172:173], v[172:173], v[176:177] neg_lo:[0,1] neg_hi:[0,1]
    v_pk_add_f32 v[174:175], v[174:175], v[178:179] neg_lo:[0,1] neg_hi:[0,1]
    v_pk_fma_f32 v[168:169], v[180:181], v[172:173], v[168:169] neg_lo:[1,0,0] neg_hi:[1,0,0]
    v_pk_fma_f32 v[170:171], v[180:181], v[174:175], v[170:171] neg_lo:[1,0,0] neg_hi:[1,0,0]
    v_pk_mul_f32 v[172:173], v[182:183], v[172:173]
    v_pk_mul_f32 v[174:175], v[182:183], v[174:175]
    v_pk_mul_f32 v[176:177], v[168:169], v[116:117]
    v_pk_mul_f32 v[178:179], v[168:169], v[132:133]
    v_pk_fma_f32 v[176:177], v[170:171], v[132:133], v[176:177] neg_lo:[1,0,0] neg_hi:[1,0,0]
    v_pk_fma_f32 v[178:179], v[170:171], v[116:117], v[178:179]
    v_pk_fma_f32 v[176:177], v[174:175], v[148:149], v[176:177] neg_lo:[1,0,0] neg_hi:[1,0,0]
    v_pk_fma_f32 v[178:179], v[172:173], v[148:149], v[178:179]
    v_pk_fma_f32 v[176:177], v[172:173], v[164:165], v[176:177] neg_lo:[1,0,0] neg_hi:[1,0,0]
    v_pk_fma_f32 v[178:179], v[174:175], v[164:165], v[178:179] neg_lo:[1,0,0] neg_hi:[1,0,0]
    v_cvt_pk_bf16_f32 v36, v178, v176
    v_cvt_pk_bf16_f32 v37, v179, v177
    v_lshlrev_b32 v172, 16, v70
    v_and_b32 v174, s56, v70
    v_lshlrev_b32 v173, 16, v71
    v_and_b32 v175, s56, v71
    v_lshlrev_b32 v176, 16, v86
    v_and_b32 v178, s56, v86
    v_lshlrev_b32 v177, 16, v87
    v_and_b32 v179, s56, v87
    v_lshlrev_b32 v180, 16, v102
    v_and_b32 v182, s56, v102
    v_lshlrev_b32 v181, 16, v103
    v_and_b32 v183, s56, v103
    v_pk_add_f32 v[168:169], v[172:173], v[176:177]
    v_pk_add_f32 v[170:171], v[174:175], v[178:179]
    v_pk_add_f32 v[172:173], v[172:173], v[176:177] neg_lo:[0,1] neg_hi:[0,1]
    v_pk_add_f32 v[174:175], v[174:175], v[178:179] neg_lo:[0,1] neg_hi:[0,1]
    v_pk_fma_f32 v[168:169], v[180:181], v[172:173], v[168:169] neg_lo:[1,0,0] neg_hi:[1,0,0]
    v_pk_fma_f32 v[170:171], v[180:181], v[174:175], v[170:171] neg_lo:[1,0,0] neg_hi:[1,0,0]
    v_pk_mul_f32 v[172:173], v[182:183], v[172:173]
    v_pk_mul_f32 v[174:175], v[182:183], v[174:175]
    v_pk_mul_f32 v[176:177], v[168:169], v[118:119]
    v_pk_mul_f32 v[178:179], v[168:169], v[134:135]
    v_pk_fma_f32 v[176:177], v[170:171], v[134:135], v[176:177] neg_lo:[1,0,0] neg_hi:[1,0,0]
    v_pk_fma_f32 v[178:179], v[170:171], v[118:119], v[178:179]
    v_pk_fma_f32 v[176:177], v[174:175], v[150:151], v[176:177] neg_lo:[1,0,0] neg_hi:[1,0,0]
    v_pk_fma_f32 v[178:179], v[172:173], v[150:151], v[178:179]
    v_pk_fma_f32 v[176:177], v[172:173], v[166:167], v[176:177] neg_lo:[1,0,0] neg_hi:[1,0,0]
    v_pk_fma_f32 v[178:179], v[174:175], v[166:167], v[178:179] neg_lo:[1,0,0] neg_hi:[1,0,0]
    v_cvt_pk_bf16_f32 v38, v178, v176
    v_cvt_pk_bf16_f32 v39, v179, v177
    v_mfma_f32_32x32x16_bf16 v[120:135], v[24:27], v[192:195], 0
    v_mfma_f32_32x32x16_bf16 v[104:119], v[24:27], v[208:211], 0
    v_mfma_f32_32x32x16_bf16 v[120:135], v[28:31], v[196:199], v[120:135]
    v_mfma_f32_32x32x16_bf16 v[104:119], v[28:31], v[212:215], v[104:119]
    v_mfma_f32_32x32x16_bf16 v[120:135], v[32:35], v[200:203], v[120:135]
    v_mfma_f32_32x32x16_bf16 v[104:119], v[32:35], v[216:219], v[104:119]
    v_mfma_f32_32x32x16_bf16 v[120:135], v[36:39], v[204:207], v[120:135]
    v_mfma_f32_32x32x16_bf16 v[104:119], v[36:39], v[220:223], v[104:119]
    s_nop 11
    v_pk_mul_f32 v[168:169], v[104:105], v[224:225]
    v_pk_mul_f32 v[170:171], v[120:121], v[224:225]
    v_pk_mul_f32 v[172:173], v[106:107], v[226:227]
    v_pk_mul_f32 v[174:175], v[122:123], v[226:227]
    v_pk_fma_f32 v[168:169], v[120:121], v[240:241], v[168:169] neg_lo:[1,0,0] neg_hi:[1,0,0]
    v_pk_fma_f32 v[170:171], v[104:105], v[240:241], v[170:171]
    v_pk_fma_f32 v[172:173], v[122:123], v[242:243], v[172:173] neg_lo:[1,0,0] neg_hi:[1,0,0]
    v_pk_fma_f32 v[174:175], v[106:107], v[242:243], v[174:175]
    v_cvt_pk_bf16_f32 v24, v170, v168
    v_cvt_pk_bf16_f32 v25, v171, v169
    v_cvt_pk_bf16_f32 v26, v174, v172
    v_cvt_pk_bf16_f32 v27, v175, v173
    v_pk_mul_f32 v[168:169], v[108:109], v[228:229]
    v_pk_mul_f32 v[170:171], v[124:125], v[228:229]
    v_pk_mul_f32 v[172:173], v[110:111], v[230:231]
    v_pk_mul_f32 v[174:175], v[126:127], v[230:231]
    v_pk_fma_f32 v[168:169], v[124:125], v[244:245], v[168:169] neg_lo:[1,0,0] neg_hi:[1,0,0]
    v_pk_fma_f32 v[170:171], v[108:109], v[244:245], v[170:171]
    v_pk_fma_f32 v[172:173], v[126:127], v[246:247], v[172:173] neg_lo:[1,0,0] neg_hi:[1,0,0]
    v_pk_fma_f32 v[174:175], v[110:111], v[246:247], v[174:175]
    v_cvt_pk_bf16_f32 v28, v170, v168
    v_cvt_pk_bf16_f32 v29, v171, v169
    v_cvt_pk_bf16_f32 v30, v174, v172
    v_cvt_pk_bf16_f32 v31, v175, v173
    v_pk_mul_f32 v[168:169], v[112:113], v[232:233]
    v_pk_mul_f32 v[170:171], v[128:129], v[232:233]
    v_pk_mul_f32 v[172:173], v[114:115], v[234:235]
    v_pk_mul_f32 v[174:175], v[130:131], v[234:235]
    v_pk_fma_f32 v[168:169], v[128:129], v[248:249], v[168:169] neg_lo:[1,0,0] neg_hi:[1,0,0]
    v_pk_fma_f32 v[170:171], v[112:113], v[248:249], v[170:171]
    v_pk_fma_f32 v[172:173], v[130:131], v[250:251], v[172:173] neg_lo:[1,0,0] neg_hi:[1,0,0]
    v_pk_fma_f32 v[174:175], v[114:115], v[250:251], v[174:175]
    v_cvt_pk_bf16_f32 v32, v170, v168
    v_cvt_pk_bf16_f32 v33, v171, v169
    v_cvt_pk_bf16_f32 v34, v174, v172
    v_cvt_pk_bf16_f32 v35, v175, v173
    v_pk_mul_f32 v[168:169], v[116:117], v[236:237]
    v_pk_mul_f32 v[170:171], v[132:133], v[236:237]
    v_pk_mul_f32 v[172:173], v[118:119], v[238:239]
    v_pk_mul_f32 v[174:175], v[134:135], v[238:239]
    v_pk_fma_f32 v[168:169], v[132:133], v[252:253], v[168:169] neg_lo:[1,0,0] neg_hi:[1,0,0]
    v_pk_fma_f32 v[170:171], v[116:117], v[252:253], v[170:171]
    v_pk_fma_f32 v[172:173], v[134:135], v[254:255], v[172:173] neg_lo:[1,0,0] neg_hi:[1,0,0]
    v_pk_fma_f32 v[174:175], v[118:119], v[254:255], v[174:175]
    v_cvt_pk_bf16_f32 v36, v170, v168
    v_cvt_pk_bf16_f32 v37, v171, v169
    v_cvt_pk_bf16_f32 v38, v174, v172
    v_cvt_pk_bf16_f32 v39, v175, v173
    v_mfma_f32_32x32x16_bf16 v[120:135], v[192:195], v[24:27], 0
    v_mfma_f32_32x32x16_bf16 v[104:119], v[208:211], v[24:27], 0
    v_mfma_f32_32x32x16_bf16 v[120:135], v[196:199], v[28:31], v[120:135]
    v_mfma_f32_32x32x16_bf16 v[104:119], v[212:215], v[28:31], v[104:119]
    v_mfma_f32_32x32x16_bf16 v[120:135], v[200:203], v[32:35], v[120:135]
    v_mfma_f32_32x32x16_bf16 v[104:119], v[216:219], v[32:35], v[104:119]
    v_mfma_f32_32x32x16_bf16 v[120:135], v[204:207], v[36:39], v[120:135]
    v_mfma_f32_32x32x16_bf16 v[104:119], v[220:223], v[36:39], v[104:119]
    s_nop 11
    v_cvt_pk_bf16_f32 v24, v120, v104
    v_cvt_pk_bf16_f32 v25, v121, v105
    v_cvt_pk_bf16_f32 v26, v122, v106
    v_cvt_pk_bf16_f32 v27, v123, v107
    v_xor_b32 v24, s50, v24
    v_xor_b32 v25, s50, v25
    v_xor_b32 v26, s50, v26
    v_xor_b32 v27, s50, v27
    buffer_store_dwordx4 v[24:27], v18, s[12:15], s53 offen offset:0 sc1
    v_cvt_pk_bf16_f32 v28, v124, v108
    v_cvt_pk_bf16_f32 v29, v125, v109
    v_cvt_pk_bf16_f32 v30, v126, v110
    v_cvt_pk_bf16_f32 v31, v127, v111
    v_xor_b32 v28, s50, v28
    v_xor_b32 v29, s50, v29
    v_xor_b32 v30, s50, v30
    v_xor_b32 v31, s50, v31
    buffer_store_dwordx4 v[28:31], v18, s[12:15], s53 offen offset:1024 sc1
    v_cvt_pk_bf16_f32 v32, v128, v112
    v_cvt_pk_bf16_f32 v33, v129, v113
    v_cvt_pk_bf16_f32 v34, v130, v114
    v_cvt_pk_bf16_f32 v35, v131, v115
    v_xor_b32 v32, s50, v32
    v_xor_b32 v33, s50, v33
    v_xor_b32 v34, s50, v34
    v_xor_b32 v35, s50, v35
    buffer_store_dwordx4 v[32:35], v18, s[12:15], s53 offen offset:2048 sc1
    v_cvt_pk_bf16_f32 v36, v132, v116
    v_cvt_pk_bf16_f32 v37, v133, v117
    v_cvt_pk_bf16_f32 v38, v134, v118
    v_cvt_pk_bf16_f32 v39, v135, v119
    v_xor_b32 v36, s50, v36
    v_xor_b32 v37, s50, v37
    v_xor_b32 v38, s50, v38
    v_xor_b32 v39, s50, v39
    buffer_store_dwordx4 v[36:39], v18, s[12:15], s53 offen offset:3072 sc1
    s_branch L_f2end
L_F:
L_Ft:
    v_lshlrev_b32 v18, 4, v1
    v_mov_b32 v20, 131072
    s_mov_b32 s40, 0
lw_69:
    ds_read_b128 v[24:27], v20 offset:64
    s_add_u32 s40, s40, 1
    s_waitcnt lgkmcnt(0)
    v_min3_u32 v24, v24, v25, v26
    v_min_u32 v24, v24, v27
    v_cmp_gt_u32 vcc, 1, v24
    s_cbranch_vccz lwx_70
    s_sleep 1
    s_cmp_lt_u32 s40, 3200000
    s_cbranch_scc1 lw_69
lwx_70:
    ds_read_b128 v[24:27], v16 offset:0
    ds_read_b128 v[28:31], v16 offset:12288
    ds_read_b128 v[32:35], v16 offset:24576
    ds_read_b128 v[36:39], v16 offset:36864
    ds_read_b128 v[40:43], v17 offset:0
    ds_read_b128 v[44:47], v17 offset:12288
    ds_read_b128 v[48:51], v17 offset:24576
    ds_read_b128 v[52:55], v17 offset:36864
L_f2body:
    s_waitcnt lgkmcnt(4)
    s_brev_b32 s57, 1
    s_mov_b32 s56, 0xffff0000
    v_mfma_f32_32x32x16_bf16 v[104:119], v[24:27], v[192:195], 0
    s_waitcnt lgkmcnt(0)
    v_xor_b32 v40, s57, v40
    v_mfma_f32_32x32x16_bf16 v[120:135], v[24:27], v[208:211], 0
    v_xor_b32 v41, s57, v41
    v_xor_b32 v42, s57, v42
    v_mfma_f32_32x32x16_bf16 v[104:119], v[28:31], v[196:199], v[104:119]
    v_xor_b32 v43, s57, v43
    v_xor_b32 v44, s57, v44
    v_mfma_f32_32x32x16_bf16 v[120:135], v[28:31], v[212:215], v[120:135]
    v_xor_b32 v45, s57, v45
    v_xor_b32 v46, s57, v46
    v_mfma_f32_32x32x16_bf16 v[104:119], v[32:35], v[200:203], v[104:119]
    v_xor_b32 v47, s57, v47
    v_xor_b32 v48, s57, v48
    v_mfma_f32_32x32x16_bf16 v[120:135], v[32:35], v[216:219], v[120:135]
    v_xor_b32 v49, s57, v49
    v_xor_b32 v50, s57, v50
    v_mfma_f32_32x32x16_bf16 v[104:119], v[36:39], v[204:207], v[104:119]
    v_xor_b32 v51, s57, v51
    v_xor_b32 v52, s57, v52
    v_mfma_f32_32x32x16_bf16 v[120:135], v[36:39], v[220:223], v[120:135]
    v_xor_b32 v53, s57, v53
    v_xor_b32 v54, s57, v54
    v_xor_b32 v55, s57, v55
    v_mfma_f32_32x32x16_bf16 v[136:151], v[40:43], v[192:195], 0
    s_nop 4
    v_mul_f32 v168, v104, v224
    s_nop 1
    v_mul_f32 v169, v120, v224
    v_mul_f32 v170, v105, v225
    v_mul_f32 v171, v121, v225
    v_mul_f32 v172, v106, v226
    v_mul_f32 v173, v122, v226
    v_mul_f32 v174, v107, v227
    v_mul_f32 v175, v123, v227
    v_fmac_f32 v168, v120, v240
    v_fma_f32 v169, -v104, v240, v169
    v_mfma_f32_32x32x16_bf16 v[152:167], v[40:43], v[208:211], 0
    v_fmac_f32 v170, v121, v241
    v_fma_f32 v171, -v105, v241, v171
    v_fmac_f32 v172, v122, v242
    v_fma_f32 v173, -v106, v242, v173
    v_fmac_f32 v174, v123, v243
    v_fma_f32 v175, -v107, v243, v175
    v_cvt_pk_bf16_f32 v24, v168, v169
    v_cvt_pk_bf16_f32 v25, v170, v171
    v_cvt_pk_bf16_f32 v26, v172, v173
    v_cvt_pk_bf16_f32 v27, v174, v175
    v_mfma_f32_32x32x16_bf16 v[136:151], v[44:47], v[196:199], v[136:151]
    v_mul_f32 v168, v108, v228
    v_mul_f32 v169, v124, v228
    v_mul_f32 v170, v109, v229
    v_mul_f32 v171, v125, v229
    v_mul_f32 v172, v110, v230
    v_mul_f32 v173, v126, v230
    v_mul_f32 v174, v111, v231
    v_mul_f32 v175, v127, v231
    v_fmac_f32 v168, v124, v244
    v_fma_f32 v169, -v108, v244, v169
    v_mfma_f32_32x32x16_bf16 v[152:167], v[44:47], v[212:215], v[152:167]
    v_fmac_f32 v170, v125, v245
    v_fma_f32 v171, -v109, v245, v171
    v_fmac_f32 v172, v126, v246
    v_fma_f32 v173, -v110, v246, v173
    v_fmac_f32 v174, v127, v247
    v_fma_f32 v175, -v111, v247, v175
    v_cvt_pk_bf16_f32 v28, v168, v169
    v_cvt_pk_bf16_f32 v29, v170, v171
    v_cvt_pk_bf16_f32 v30, v172, v173
    v_cvt_pk_bf16_f32 v31, v174, v175
    v_mfma_f32_32x32x16_bf16 v[136:151], v[48:51], v[200:203], v[136:151]
    v_mul_f32 v168, v112, v232
    v_mul_f32 v169, v128, v232
    v_mul_f32 v170, v113, v233
    v_mul_f32 v171, v129, v233
    v_mul_f32 v172, v114, v234
    v_mul_f32 v173, v130, v234
    v_mul_f32 v174, v115, v235
    v_mul_f32 v175, v131, v235
    v_fmac_f32 v168, v128, v248
    v_fma_f32 v169, -v112, v248, v169
    v_mfma_f32_32x32x16_bf16 v[152:167], v[48:51], v[216:219], v[152:167]
    v_fmac_f32 v170, v129, v249
    v_fma_f32 v171, -v113, v249, v171
    v_fmac_f32 v172, v130, v250
    v_fma_f32 v173, -v114, v250, v173
    v_fmac_f32 v174, v131, v251
    v_fma_f32 v175, -v115, v251, v175
    v_cvt_pk_bf16_f32 v32, v168, v169
    v_cvt_pk_bf16_f32 v33, v170, v171
    v_cvt_pk_bf16_f32 v34, v172, v173
    v_cvt_pk_bf16_f32 v35, v174, v175
    v_mfma_f32_32x32x16_bf16 v[136:151], v[52:55], v[204:207], v[136:151]
    v_mul_f32 v168, v116, v236
    v_mul_f32 v169, v132, v236
    v_mul_f32 v170, v117, v237
    v_mul_f32 v171, v133, v237
    v_mul_f32 v172, v118, v238
    v_mul_f32 v173, v134, v238
    v_mul_f32 v174, v119, v239
    v_mul_f32 v175, v135, v239
    v_fmac_f32 v168, v132, v252
    v_fma_f32 v169, -v116, v252, v169
    v_mfma_f32_32x32x16_bf16 v[152:167], v[52:55], v[220:223], v[152:167]
    v_fmac_f32 v170, v133, v253
    v_fma_f32 v171, -v117, v253, v171
    v_fmac_f32 v172, v134, v254
    v_fma_f32 v173, -v118, v254, v173
    v_fmac_f32 v174, v135, v255
    v_fma_f32 v175, -v119, v255, v175
    v_cvt_pk_bf16_f32 v36, v168, v169
    v_cvt_pk_bf16_f32 v37, v170, v171
    v_cvt_pk_bf16_f32 v38, v172, v173
    v_cvt_pk_bf16_f32 v39, v174, v175
    v_mfma_f32_32x32x16_bf16 v[104:119], v[192:195], v[24:27], 0
    v_mul_f32 v168, v136, v224
    v_mul_f32 v169, v152, v224
    v_mul_f32 v170, v137, v225
    v_mul_f32 v171, v153, v225
    v_mul_f32 v172, v138, v226
    v_mul_f32 v173, v154, v226
    v_mul_f32 v174, v139, v227
    v_mul_f32 v175, v155, v227
    v_fmac_f32 v168, v152, v240
    v_fma_f32 v169, -v136, v240, v169
    v_mfma_f32_32x32x16_bf16 v[120:135], v[208:211], v[24:27], 0
    v_fmac_f32 v170, v153, v241
    v_fma_f32 v171, -v137, v241, v171
    v_fmac_f32 v172, v154, v242
    v_fma_f32 v173, -v138, v242, v173
    v_fmac_f32 v174, v155, v243
    v_fma_f32 v175, -v139, v243, v175
    v_cvt_pk_bf16_f32 v40, v168, v169
    v_cvt_pk_bf16_f32 v41, v170, v171
    v_cvt_pk_bf16_f32 v42, v172, v173
    v_cvt_pk_bf16_f32 v43, v174, v175
    v_mfma_f32_32x32x16_bf16 v[104:119], v[196:199], v[28:31], v[104:119]
    v_mul_f32 v168, v140, v228
    v_mul_f32 v169, v156, v228
    v_mul_f32 v170, v141, v229
    v_mul_f32 v171, v157, v229
    v_mul_f32 v172, v142, v230
    v_mul_f32 v173, v158, v230
    v_mul_f32 v174, v143, v231
    v_mul_f32 v175, v159, v231
    v_fmac_f32 v168, v156, v244
    v_fma_f32 v169, -v140, v244, v169
    v_mfma_f32_32x32x16_bf16 v[120:135], v[212:215], v[28:31], v[120:135]
    v_fmac_f32 v170, v157, v245
    v_fma_f32 v171, -v141, v245, v171
    v_fmac_f32 v172, v158, v246
    v_fma_f32 v173, -v142, v246, v173
    v_fmac_f32 v174, v159, v247
    v_fma_f32 v175, -v143, v247, v175
    v_cvt_pk_bf16_f32 v44, v168, v169
    v_cvt_pk_bf16_f32 v45, v170, v171
    v_cvt_pk_bf16_f32 v46, v172, v173
    v_cvt_pk_bf16_f32 v47, v174, v175
    v_mfma_f32_32x32x16_bf16 v[104:119], v[200:203], v[32:35], v[104:119]
    v_mul_f32 v168, v144, v232
    v_mul_f32 v169, v160, v232
    v_mul_f32 v170, v145, v233
    v_mul_f32 v171, v161, v233
    v_mul_f32 v172, v146, v234
    v_mul_f32 v173, v162, v234
    v_mul_f32 v174, v147, v235
    v_mul_f32 v175, v163, v235
    v_fmac_f32 v168, v160, v248
    v_fma_f32 v169, -v144, v248, v169
    v_mfma_f32_32x32x16_bf16 v[120:135], v[216:219], v[32:35], v[120:135]
    v_fmac_f32 v170, v161, v249
    v_fma_f32 v171, -v145, v249, v171
    v_fmac_f32 v172, v162, v250
    v_fma_f32 v173, -v146, v250, v173
    v_fmac_f32 v174, v163, v251
    v_fma_f32 v175, -v147, v251, v175
    v_cvt_pk_bf16_f32 v48, v168, v169
    v_cvt_pk_bf16_f32 v49, v170, v171
    v_cvt_pk_bf16_f32 v50, v172, v173
    v_cvt_pk_bf16_f32 v51, v174, v175
    v_mfma_f32_32x32x16_bf16 v[104:119], v[204:207], v[36:39], v[104:119]
    v_mul_f32 v168, v148, v236
    v_mul_f32 v169, v164, v236
    v_mul_f32 v170, v149, v237
    v_mul_f32 v171, v165, v237
    v_mul_f32 v172, v150, v238
    v_mul_f32 v173, v166, v238
    v_mul_f32 v174, v151, v239
    v_mul_f32 v175, v167, v239
    v_fmac_f32 v168, v164, v252
    v_fma_f32 v169, -v148, v252, v169
    v_mfma_f32_32x32x16_bf16 v[120:135], v[220:223], v[36:39], v[120:135]
    v_fmac_f32 v170, v165, v253
    v_fma_f32 v171, -v149, v253, v171
    v_fmac_f32 v172, v166, v254
    v_fma_f32 v173, -v150, v254, v173
    v_fmac_f32 v174, v167, v255
    v_fma_f32 v175, -v151, v255, v175
    v_cvt_pk_bf16_f32 v52, v168, v169
    v_cvt_pk_bf16_f32 v53, v170, v171
    v_cvt_pk_bf16_f32 v54, v172, v173
    v_cvt_pk_bf16_f32 v55, v174, v175
    v_mfma_f32_32x32x16_bf16 v[136:151], v[192:195], v[40:43], 0
    v_mfma_f32_32x32x16_bf16 v[152:167], v[208:211], v[40:43], 0
    v_mfma_f32_32x32x16_bf16 v[136:151], v[196:199], v[44:47], v[136:151]
    v_mfma_f32_32x32x16_bf16 v[152:167], v[212:215], v[44:47], v[152:167]
    v_mfma_f32_32x32x16_bf16 v[136:151], v[200:203], v[48:51], v[136:151]
    v_mfma_f32_32x32x16_bf16 v[152:167], v[216:219], v[48:51], v[152:167]
    v_mfma_f32_32x32x16_bf16 v[136:151], v[204:207], v[52:55], v[136:151]
    v_mfma_f32_32x32x16_bf16 v[152:167], v[220:223], v[52:55], v[152:167]
    s_mov_b32 s40, 0
lw_71:
    ds_read_b128 v[168:171], v20 offset:80
    s_add_u32 s40, s40, 1
    s_waitcnt lgkmcnt(0)
    v_min3_u32 v168, v168, v169, v170
    v_min_u32 v168, v168, v171
    v_cmp_gt_u32 vcc, 1, v168
    s_cbranch_vccz lwx_72
    s_sleep 1
    s_cmp_lt_u32 s40, 3200000
    s_cbranch_scc1 lw_71
lwx_72:
    ds_read_b128 v[56:59], v19 offset:0
    ds_read_b128 v[72:75], v19 offset:64
    ds_read_b128 v[60:63], v19 offset:2048
    ds_read_b128 v[76:79], v19 offset:2112
    ds_read_b128 v[64:67], v19 offset:4096
    ds_read_b128 v[80:83], v19 offset:4160
    ds_read_b128 v[68:71], v19 offset:6144
    ds_read_b128 v[84:87], v19 offset:6208
    s_waitcnt lgkmcnt(6)
    v_lshlrev_b32 v172, 16, v56
    v_and_b32 v174, s56, v56
    v_lshlrev_b32 v173, 16, v57
    v_and_b32 v175, s56, v57
    v_lshlrev_b32 v180, 16, v72
    v_and_b32 v182, s56, v72
    v_lshlrev_b32 v181, 16, v73
    v_and_b32 v183, s56, v73
    v_lshlrev_b32 v184, 16, v88
    v_and_b32 v186, s56, v88
    v_lshlrev_b32 v185, 16, v89
    v_and_b32 v187, s56, v89
    v_pk_add_f32 v[176:177], v[172:173], v[180:181]
    v_pk_add_f32 v[178:179], v[174:175], v[182:183]
    v_pk_add_f32 v[172:173], v[172:173], v[180:181] neg_lo:[0,1] neg_hi:[0,1]
    v_pk_add_f32 v[174:175], v[174:175], v[182:183] neg_lo:[0,1] neg_hi:[0,1]
    v_pk_fma_f32 v[168:169], v[184:185], v[172:173], v[176:177] neg_lo:[1,0,0] neg_hi:[1,0,0]
    v_pk_fma_f32 v[170:171], v[184:185], v[174:175], v[178:179] neg_lo:[1,0,0] neg_hi:[1,0,0]
    v_pk_fma_f32 v[176:177], v[184:185], v[172:173], v[176:177]
    v_pk_fma_f32 v[178:179], v[184:185], v[174:175], v[178:179]
    v_pk_mul_f32 v[172:173], v[186:187], v[172:173]
    v_pk_mul_f32 v[174:175], v[186:187], v[174:175]
    v_pk_mul_f32 v[180:181], v[168:169], v[104:105]
    v_pk_mul_f32 v[182:183], v[168:169], v[120:121]
    v_pk_mul_f32 v[184:185], v[174:175], v[104:105]
    v_pk_mul_f32 v[186:187], v[174:175], v[120:121]
    v_pk_fma_f32 v[180:181], v[170:171], v[120:121], v[180:181] neg_lo:[1,0,0] neg_hi:[1,0,0]
    v_pk_fma_f32 v[182:183], v[170:171], v[104:105], v[182:183]
    v_pk_fma_f32 v[184:185], v[172:173], v[120:121], v[184:185]
    v_pk_fma_f32 v[186:187], v[172:173], v[104:105], v[186:187] neg_lo:[1,0,0] neg_hi:[1,0,0]
    v_pk_fma_f32 v[180:181], v[174:175], v[136:137], v[180:181] neg_lo:[1,0,0] neg_hi:[1,0,0]
    v_pk_fma_f32 v[182:183], v[172:173], v[136:137], v[182:183]
    v_pk_fma_f32 v[184:185], v[176:177], v[136:137], v[184:185]
    v_pk_fma_f32 v[186:187], v[176:177], v[152:153], v[186:187]
    v_pk_fma_f32 v[180:181], v[172:173], v[152:153], v[180:181] neg_lo:[1,0,0] neg_hi:[1,0,0]
    v_pk_fma_f32 v[182:183], v[174:175], v[152:153], v[182:183] neg_lo:[1,0,0] neg_hi:[1,0,0]
    v_pk_fma_f32 v[184:185], v[178:179], v[152:153], v[184:185] neg_lo:[1,0,0] neg_hi:[1,0,0]
    v_pk_fma_f32 v[186:187], v[178:179], v[136:137], v[186:187]
    v_cvt_pk_bf16_f32 v24, v182, v180
    v_cvt_pk_bf16_f32 v40, v186, v184
    v_cvt_pk_bf16_f32 v25, v183, v181
    v_cvt_pk_bf16_f32 v41, v187, v185
    v_lshlrev_b32 v172, 16, v58
    v_and_b32 v174, s56, v58
    v_lshlrev_b32 v173, 16, v59
    v_and_b32 v175, s56, v59
    v_lshlrev_b32 v180, 16, v74
    v_and_b32 v182, s56, v74
    v_lshlrev_b32 v181, 16, v75
    v_and_b32 v183, s56, v75
    v_lshlrev_b32 v184, 16, v90
    v_and_b32 v186, s56, v90
    v_lshlrev_b32 v185, 16, v91
    v_and_b32 v187, s56, v91
    v_pk_add_f32 v[176:177], v[172:173], v[180:181]
    v_pk_add_f32 v[178:179], v[174:175], v[182:183]
    v_pk_add_f32 v[172:173], v[172:173], v[180:181] neg_lo:[0,1] neg_hi:[0,1]
    v_pk_add_f32 v[174:175], v[174:175], v[182:183] neg_lo:[0,1] neg_hi:[0,1]
    v_pk_fma_f32 v[168:169], v[184:185], v[172:173], v[176:177] neg_lo:[1,0,0] neg_hi:[1,0,0]
    v_pk_fma_f32 v[170:171], v[184:185], v[174:175], v[178:179] neg_lo:[1,0,0] neg_hi:[1,0,0]
    v_pk_fma_f32 v[176:177], v[184:185], v[172:173], v[176:177]
    v_pk_fma_f32 v[178:179], v[184:185], v[174:175], v[178:179]
    v_pk_mul_f32 v[172:173], v[186:187], v[172:173]
    v_pk_mul_f32 v[174:175], v[186:187], v[174:175]
    v_pk_mul_f32 v[180:181], v[168:169], v[106:107]
    v_pk_mul_f32 v[182:183], v[168:169], v[122:123]
    v_pk_mul_f32 v[184:185], v[174:175], v[106:107]
    v_pk_mul_f32 v[186:187], v[174:175], v[122:123]
    v_pk_fma_f32 v[180:181], v[170:171], v[122:123], v[180:181] neg_lo:[1,0,0] neg_hi:[1,0,0]
    v_pk_fma_f32 v[182:183], v[170:171], v[106:107], v[182:183]
    v_pk_fma_f32 v[184:185], v[172:173], v[122:123], v[184:185]
    v_pk_fma_f32 v[186:187], v[172:173], v[106:107], v[186:187] neg_lo:[1,0,0] neg_hi:[1,0,0]
    v_pk_fma_f32 v[180:181], v[174:175], v[138:139], v[180:181] neg_lo:[1,0,0] neg_hi:[1,0,0]
    v_pk_fma_f32 v[182:183], v[172:173], v[138:139], v[182:183]
    v_pk_fma_f32 v[184:185], v[176:177], v[138:139], v[184:185]
    v_pk_fma_f32 v[186:187], v[176:177], v[154:155], v[186:187]
    v_pk_fma_f32 v[180:181], v[172:173], v[154:155], v[180:181] neg_lo:[1,0,0] neg_hi:[1,0,0]
    v_pk_fma_f32 v[182:183], v[174:175], v[154:155], v[182:183] neg_lo:[1,0,0] neg_hi:[1,0,0]
    v_pk_fma_f32 v[184:185], v[178:179], v[154:155], v[184:185] neg_lo:[1,0,0] neg_hi:[1,0,0]
    v_pk_fma_f32 v[186:187], v[178:179], v[138:139], v[186:187]
    v_cvt_pk_bf16_f32 v26, v182, v180
    v_cvt_pk_bf16_f32 v42, v186, v184
    v_cvt_pk_bf16_f32 v27, v183, v181
    v_cvt_pk_bf16_f32 v43, v187, v185
    s_waitcnt lgkmcnt(4)
    v_lshlrev_b32 v172, 16, v60
    v_and_b32 v174, s56, v60
    v_lshlrev_b32 v173, 16, v61
    v_and_b32 v175, s56, v61
    v_lshlrev_b32 v180, 16, v76
    v_and_b32 v182, s56, v76
    v_lshlrev_b32 v181, 16, v77
    v_and_b32 v183, s56, v77
    v_lshlrev_b32 v184, 16, v92
    v_and_b32 v186, s56, v92
    v_lshlrev_b32 v185, 16, v93
    v_and_b32 v187, s56, v93
    v_pk_add_f32 v[176:177], v[172:173], v[180:181]
    v_pk_add_f32 v[178:179], v[174:175], v[182:183]
    v_pk_add_f32 v[172:173], v[172:173], v[180:181] neg_lo:[0,1] neg_hi:[0,1]
    v_pk_add_f32 v[174:175], v[174:175], v[182:183] neg_lo:[0,1] neg_hi:[0,1]
    v_pk_fma_f32 v[168:169], v[184:185], v[172:173], v[176:177] neg_lo:[1,0,0] neg_hi:[1,0,0]
    v_pk_fma_f32 v[170:171], v[184:185], v[174:175], v[178:179] neg_lo:[1,0,0] neg_hi:[1,0,0]
    v_pk_fma_f32 v[176:177], v[184:185], v[172:173], v[176:177]
    v_pk_fma_f32 v[178:179], v[184:185], v[174:175], v[178:179]
    v_pk_mul_f32 v[172:173], v[186:187], v[172:173]
    v_pk_mul_f32 v[174:175], v[186:187], v[174:175]
    v_pk_mul_f32 v[180:181], v[168:169], v[108:109]
    v_pk_mul_f32 v[182:183], v[168:169], v[124:125]
    v_pk_mul_f32 v[184:185], v[174:175], v[108:109]
    v_pk_mul_f32 v[186:187], v[174:175], v[124:125]
    v_pk_fma_f32 v[180:181], v[170:171], v[124:125], v[180:181] neg_lo:[1,0,0] neg_hi:[1,0,0]
    v_pk_fma_f32 v[182:183], v[170:171], v[108:109], v[182:183]
    v_pk_fma_f32 v[184:185], v[172:173], v[124:125], v[184:185]
    v_pk_fma_f32 v[186:187], v[172:173], v[108:109], v[186:187] neg_lo:[1,0,0] neg_hi:[1,0,0]
    v_pk_fma_f32 v[180:181], v[174:175], v[140:141], v[180:181] neg_lo:[1,0,0] neg_hi:[1,0,0]
    v_pk_fma_f32 v[182:183], v[172:173], v[140:141], v[182:183]
    v_pk_fma_f32 v[184:185], v[176:177], v[140:141], v[184:185]
    v_pk_fma_f32 v[186:187], v[176:177], v[156:157], v[186:187]
    v_pk_fma_f32 v[180:181], v[172:173], v[156:157], v[180:181] neg_lo:[1,0,0] neg_hi:[1,0,0]
    v_pk_fma_f32 v[182:183], v[174:175], v[156:157], v[182:183] neg_lo:[1,0,0] neg_hi:[1,0,0]
    v_pk_fma_f32 v[184:185], v[178:179], v[156:157], v[184:185] neg_lo:[1,0,0] neg_hi:[1,0,0]
    v_pk_fma_f32 v[186:187], v[178:179], v[140:141], v[186:187]
    v_cvt_pk_bf16_f32 v28, v182, v180
    v_cvt_pk_bf16_f32 v44, v186, v184
    v_cvt_pk_bf16_f32 v29, v183, v181
    v_cvt_pk_bf16_f32 v45, v187, v185
    v_lshlrev_b32 v172, 16, v62
    v_and_b32 v174, s56, v62
    v_lshlrev_b32 v173, 16, v63
    v_and_b32 v175, s56, v63
    v_lshlrev_b32 v180, 16, v78
    v_and_b32 v182, s56, v78
    v_lshlrev_b32 v181, 16, v79
    v_and_b32 v183, s56, v79
    v_lshlrev_b32 v184, 16, v94
    v_and_b32 v186, s56, v94
    v_lshlrev_b32 v185, 16, v95
    v_and_b32 v187, s56, v95
    v_pk_add_f32 v[176:177], v[172:173], v[180:181]
    v_pk_add_f32 v[178:179], v[174:175], v[182:183]
    v_pk_add_f32 v[172:173], v[172:173], v[180:181] neg_lo:[0,1] neg_hi:[0,1]
    v_pk_add_f32 v[174:175], v[174:175], v[182:183] neg_lo:[0,1] neg_hi:[0,1]
    v_pk_fma_f32 v[168:169], v[184:185], v[172:173], v[176:177] neg_lo:[1,0,0] neg_hi:[1,0,0]
    v_pk_fma_f32 v[170:171], v[184:185], v[174:175], v[178:179] neg_lo:[1,0,0] neg_hi:[1,0,0]
    v_pk_fma_f32 v[176:177], v[184:185], v[172:173], v[176:177]
    v_pk_fma_f32 v[178:179], v[184:185], v[174:175], v[178:179]
    v_pk_mul_f32 v[172:173], v[186:187], v[172:173]
    v_pk_mul_f32 v[174:175], v[186:187], v[174:175]
    v_pk_mul_f32 v[180:181], v[168:169], v[110:111]
    v_pk_mul_f32 v[182:183], v[168:169], v[126:127]
    v_pk_mul_f32 v[184:185], v[174:175], v[110:111]
    v_pk_mul_f32 v[186:187], v[174:175], v[126:127]
    v_pk_fma_f32 v[180:181], v[170:171], v[126:127], v[180:181] neg_lo:[1,0,0] neg_hi:[1,0,0]
    v_pk_fma_f32 v[182:183], v[170:171], v[110:111], v[182:183]
    v_pk_fma_f32 v[184:185], v[172:173], v[126:127], v[184:185]
    v_pk_fma_f32 v[186:187], v[172:173], v[110:111], v[186:187] neg_lo:[1,0,0] neg_hi:[1,0,0]
    v_pk_fma_f32 v[180:181], v[174:175], v[142:143], v[180:181] neg_lo:[1,0,0] neg_hi:[1,0,0]
    v_pk_fma_f32 v[182:183], v[172:173], v[142:143], v[182:183]
    v_pk_fma_f32 v[184:185], v[176:177], v[142:143], v[184:185]
    v_pk_fma_f32 v[186:187], v[176:177], v[158:159], v[186:187]
    v_pk_fma_f32 v[180:181], v[172:173], v[158:159], v[180:181] neg_lo:[1,0,0] neg_hi:[1,0,0]
    v_pk_fma_f32 v[182:183], v[174:175], v[158:159], v[182:183] neg_lo:[1,0,0] neg_hi:[1,0,0]
    v_pk_fma_f32 v[184:185], v[178:179], v[158:159], v[184:185] neg_lo:[1,0,0] neg_hi:[1,0,0]
    v_pk_fma_f32 v[186:187], v[178:179], v[142:143], v[186:187]
    v_cvt_pk_bf16_f32 v30, v182, v180
    v_cvt_pk_bf16_f32 v46, v186, v184
    v_cvt_pk_bf16_f32 v31, v183, v181
    v_cvt_pk_bf16_f32 v47, v187, v185
    s_waitcnt lgkmcnt(2)
    v_lshlrev_b32 v172, 16, v64
    v_and_b32 v174, s56, v64
    v_lshlrev_b32 v173, 16, v65
    v_and_b32 v175, s56, v65
    v_lshlrev_b32 v180, 16, v80
    v_and_b32 v182, s56, v80
    v_lshlrev_b32 v181, 16, v81
    v_and_b32 v183, s56, v81
    v_lshlrev_b32 v184, 16, v96
    v_and_b32 v186, s56, v96
    v_lshlrev_b32 v185, 16, v97
    v_and_b32 v187, s56, v97
    v_pk_add_f32 v[176:177], v[172:173], v[180:181]
    v_pk_add_f32 v[178:179], v[174:175], v[182:183]
    v_pk_add_f32 v[172:173], v[172:173], v[180:181] neg_lo:[0,1] neg_hi:[0,1]
    v_pk_add_f32 v[174:175], v[174:175], v[182:183] neg_lo:[0,1] neg_hi:[0,1]
    v_pk_fma_f32 v[168:169], v[184:185], v[172:173], v[176:177] neg_lo:[1,0,0] neg_hi:[1,0,0]
    v_pk_fma_f32 v[170:171], v[184:185], v[174:175], v[178:179] neg_lo:[1,0,0] neg_hi:[1,0,0]
    v_pk_fma_f32 v[176:177], v[184:185], v[172:173], v[176:177]
    v_pk_fma_f32 v[178:179], v[184:185], v[174:175], v[178:179]
    v_pk_mul_f32 v[172:173], v[186:187], v[172:173]
    v_pk_mul_f32 v[174:175], v[186:187], v[174:175]
    v_pk_mul_f32 v[180:181], v[168:169], v[112:113]
    v_pk_mul_f32 v[182:183], v[168:169], v[128:129]
    v_pk_mul_f32 v[184:185], v[174:175], v[112:113]
    v_pk_mul_f32 v[186:187], v[174:175], v[128:129]
    v_pk_fma_f32 v[180:181], v[170:171], v[128:129], v[180:181] neg_lo:[1,0,0] neg_hi:[1,0,0]
    v_pk_fma_f32 v[182:183], v[170:171], v[112:113], v[182:183]
    v_pk_fma_f32 v[184:185], v[172:173], v[128:129], v[184:185]
    v_pk_fma_f32 v[186:187], v[172:173], v[112:113], v[186:187] neg_lo:[1,0,0] neg_hi:[1,0,0]
    v_pk_fma_f32 v[180:181], v[174:175], v[144:145], v[180:181] neg_lo:[1,0,0] neg_hi:[1,0,0]
    v_pk_fma_f32 v[182:183], v[172:173], v[144:145], v[182:183]
    v_pk_fma_f32 v[184:185], v[176:177], v[144:145], v[184:185]
    v_pk_fma_f32 v[186:187], v[176:177], v[160:161], v[186:187]
    v_pk_fma_f32 v[180:181], v[172:173], v[160:161], v[180:181] neg_lo:[1,0,0] neg_hi:[1,0,0]
    v_pk_fma_f32 v[182:183], v[174:175], v[160:161], v[182:183] neg_lo:[1,0,0] neg_hi:[1,0,0]
    v_pk_fma_f32 v[184:185], v[178:179], v[160:161], v[184:185] neg_lo:[1,0,0] neg_hi:[1,0,0]
    v_pk_fma_f32 v[186:187], v[178:179], v[144:145], v[186:187]
    v_cvt_pk_bf16_f32 v32, v182, v180
    v_cvt_pk_bf16_f32 v48, v186, v184
    v_cvt_pk_bf16_f32 v33, v183, v181
    v_cvt_pk_bf16_f32 v49, v187, v185
    v_lshlrev_b32 v172, 16, v66
    v_and_b32 v174, s56, v66
    v_lshlrev_b32 v173, 16, v67
    v_and_b32 v175, s56, v67
    v_lshlrev_b32 v180, 16, v82
    v_and_b32 v182, s56, v82
    v_lshlrev_b32 v181, 16, v83
    v_and_b32 v183, s56, v83
    v_lshlrev_b32 v184, 16, v98
    v_and_b32 v186, s56, v98
    v_lshlrev_b32 v185, 16, v99
    v_and_b32 v187, s56, v99
    v_pk_add_f32 v[176:177], v[172:173], v[180:181]
    v_pk_add_f32 v[178:179], v[174:175], v[182:183]
    v_pk_add_f32 v[172:173], v[172:173], v[180:181] neg_lo:[0,1] neg_hi:[0,1]
    v_pk_add_f32 v[174:175], v[174:175], v[182:183] neg_lo:[0,1] neg_hi:[0,1]
    v_pk_fma_f32 v[168:169], v[184:185], v[172:173], v[176:177] neg_lo:[1,0,0] neg_hi:[1,0,0]
    v_pk_fma_f32 v[170:171], v[184:185], v[174:175], v[178:179] neg_lo:[1,0,0] neg_hi:[1,0,0]
    v_pk_fma_f32 v[176:177], v[184:185], v[172:173], v[176:177]
    v_pk_fma_f32 v[178:179], v[184:185], v[174:175], v[178:179]
    v_pk_mul_f32 v[172:173], v[186:187], v[172:173]
    v_pk_mul_f32 v[174:175], v[186:187], v[174:175]
    v_pk_mul_f32 v[180:181], v[168:169], v[114:115]
    v_pk_mul_f32 v[182:183], v[168:169], v[130:131]
    v_pk_mul_f32 v[184:185], v[174:175], v[114:115]
    v_pk_mul_f32 v[186:187], v[174:175], v[130:131]
    v_pk_fma_f32 v[180:181], v[170:171], v[130:131], v[180:181] neg_lo:[1,0,0] neg_hi:[1,0,0]
    v_pk_fma_f32 v[182:183], v[170:171], v[114:115], v[182:183]
    v_pk_fma_f32 v[184:185], v[172:173], v[130:131], v[184:185]
    v_pk_fma_f32 v[186:187], v[172:173], v[114:115], v[186:187] neg_lo:[1,0,0] neg_hi:[1,0,0]
    v_pk_fma_f32 v[180:181], v[174:175], v[146:147], v[180:181] neg_lo:[1,0,0] neg_hi:[1,0,0]
    v_pk_fma_f32 v[182:183], v[172:173], v[146:147], v[182:183]
    v_pk_fma_f32 v[184:185], v[176:177], v[146:147], v[184:185]
    v_pk_fma_f32 v[186:187], v[176:177], v[162:163], v[186:187]
    v_pk_fma_f32 v[180:181], v[172:173], v[162:163], v[180:181] neg_lo:[1,0,0] neg_hi:[1,0,0]
    v_pk_fma_f32 v[182:183], v[174:175], v[162:163], v[182:183] neg_lo:[1,0,0] neg_hi:[1,0,0]
    v_pk_fma_f32 v[184:185], v[178:179], v[162:163], v[184:185] neg_lo:[1,0,0] neg_hi:[1,0,0]
    v_pk_fma_f32 v[186:187], v[178:179], v[146:147], v[186:187]
    v_cvt_pk_bf16_f32 v34, v182, v180
    v_cvt_pk_bf16_f32 v50, v186, v184
    v_cvt_pk_bf16_f32 v35, v183, v181
    v_cvt_pk_bf16_f32 v51, v187, v185
    s_waitcnt lgkmcnt(0)
    v_lshlrev_b32 v172, 16, v68
    v_and_b32 v174, s56, v68
    v_lshlrev_b32 v173, 16, v69
    v_and_b32 v175, s56, v69
    v_lshlrev_b32 v180, 16, v84
    v_and_b32 v182, s56, v84
    v_lshlrev_b32 v181, 16, v85
    v_and_b32 v183, s56, v85
    v_lshlrev_b32 v184, 16, v100
    v_and_b32 v186, s56, v100
    v_lshlrev_b32 v185, 16, v101
    v_and_b32 v187, s56, v101
    v_pk_add_f32 v[176:177], v[172:173], v[180:181]
    v_pk_add_f32 v[178:179], v[174:175], v[182:183]
    v_pk_add_f32 v[172:173], v[172:173], v[180:181] neg_lo:[0,1] neg_hi:[0,1]
    v_pk_add_f32 v[174:175], v[174:175], v[182:183] neg_lo:[0,1] neg_hi:[0,1]
    v_pk_fma_f32 v[168:169], v[184:185], v[172:173], v[176:177] neg_lo:[1,0,0] neg_hi:[1,0,0]
    v_pk_fma_f32 v[170:171], v[184:185], v[174:175], v[178:179] neg_lo:[1,0,0] neg_hi:[1,0,0]
    v_pk_fma_f32 v[176:177], v[184:185], v[172:173], v[176:177]
    v_pk_fma_f32 v[178:179], v[184:185], v[174:175], v[178:179]
    v_pk_mul_f32 v[172:173], v[186:187], v[172:173]
    v_pk_mul_f32 v[174:175], v[186:187], v[174:175]
    v_pk_mul_f32 v[180:181], v[168:169], v[116:117]
    v_pk_mul_f32 v[182:183], v[168:169], v[132:133]
    v_pk_mul_f32 v[184:185], v[174:175], v[116:117]
    v_pk_mul_f32 v[186:187], v[174:175], v[132:133]
    v_pk_fma_f32 v[180:181], v[170:171], v[132:133], v[180:181] neg_lo:[1,0,0] neg_hi:[1,0,0]
    v_pk_fma_f32 v[182:183], v[170:171], v[116:117], v[182:183]
    v_pk_fma_f32 v[184:185], v[172:173], v[132:133], v[184:185]
    v_pk_fma_f32 v[186:187], v[172:173], v[116:117], v[186:187] neg_lo:[1,0,0] neg_hi:[1,0,0]
    v_pk_fma_f32 v[180:181], v[174:175], v[148:149], v[180:181] neg_lo:[1,0,0] neg_hi:[1,0,0]
    v_pk_fma_f32 v[182:183], v[172:173], v[148:149], v[182:183]
    v_pk_fma_f32 v[184:185], v[176:177], v[148:149], v[184:185]
    v_pk_fma_f32 v[186:187], v[176:177], v[164:165], v[186:187]
    v_pk_fma_f32 v[180:181], v[172:173], v[164:165], v[180:181] neg_lo:[1,0,0] neg_hi:[1,0,0]
    v_pk_fma_f32 v[182:183], v[174:175], v[164:165], v[182:183] neg_lo:[1,0,0] neg_hi:[1,0,0]
    v_pk_fma_f32 v[184:185], v[178:179], v[164:165], v[184:185] neg_lo:[1,0,0] neg_hi:[1,0,0]
    v_pk_fma_f32 v[186:187], v[178:179], v[148:149], v[186:187]
    v_cvt_pk_bf16_f32 v36, v182, v180
    v_cvt_pk_bf16_f32 v52, v186, v184
    v_cvt_pk_bf16_f32 v37, v183, v181
    v_cvt_pk_bf16_f32 v53, v187, v185
    v_lshlrev_b32 v172, 16, v70
    v_and_b32 v174, s56, v70
    v_lshlrev_b32 v173, 16, v71
    v_and_b32 v175, s56, v71
    v_lshlrev_b32 v180, 16, v86
    v_and_b32 v182, s56, v86
    v_lshlrev_b32 v181, 16, v87
    v_and_b32 v183, s56, v87
    v_lshlrev_b32 v184, 16, v102
    v_and_b32 v186, s56, v102
    v_lshlrev_b32 v185, 16, v103
    v_and_b32 v187, s56, v103
    v_pk_add_f32 v[176:177], v[172:173], v[180:181]
    v_pk_add_f32 v[178:179], v[174:175], v[182:183]
    v_pk_add_f32 v[172:173], v[172:173], v[180:181] neg_lo:[0,1] neg_hi:[0,1]
    v_pk_add_f32 v[174:175], v[174:175], v[182:183] neg_lo:[0,1] neg_hi:[0,1]
    v_pk_fma_f32 v[168:169], v[184:185], v[172:173], v[176:177] neg_lo:[1,0,0] neg_hi:[1,0,0]
    v_pk_fma_f32 v[170:171], v[184:185], v[174:175], v[178:179] neg_lo:[1,0,0] neg_hi:[1,0,0]
    v_pk_fma_f32 v[176:177], v[184:185], v[172:173], v[176:177]
    v_pk_fma_f32 v[178:179], v[184:185], v[174:175], v[178:179]
    v_pk_mul_f32 v[172:173], v[186:187], v[172:173]
    v_pk_mul_f32 v[174:175], v[186:187], v[174:175]
    v_pk_mul_f32 v[180:181], v[168:169], v[118:119]
    v_pk_mul_f32 v[182:183], v[168:169], v[134:135]
    v_pk_mul_f32 v[184:185], v[174:175], v[118:119]
    v_pk_mul_f32 v[186:187], v[174:175], v[134:135]
    v_pk_fma_f32 v[180:181], v[170:171], v[134:135], v[180:181] neg_lo:[1,0,0] neg_hi:[1,0,0]
    v_pk_fma_f32 v[182:183], v[170:171], v[118:119], v[182:183]
    v_pk_fma_f32 v[184:185], v[172:173], v[134:135], v[184:185]
    v_pk_fma_f32 v[186:187], v[172:173], v[118:119], v[186:187] neg_lo:[1,0,0] neg_hi:[1,0,0]
    v_pk_fma_f32 v[180:181], v[174:175], v[150:151], v[180:181] neg_lo:[1,0,0] neg_hi:[1,0,0]
    v_pk_fma_f32 v[182:183], v[172:173], v[150:151], v[182:183]
    v_pk_fma_f32 v[184:185], v[176:177], v[150:151], v[184:185]
    v_pk_fma_f32 v[186:187], v[176:177], v[166:167], v[186:187]
    v_pk_fma_f32 v[180:181], v[172:173], v[166:167], v[180:181] neg_lo:[1,0,0] neg_hi:[1,0,0]
    v_pk_fma_f32 v[182:183], v[174:175], v[166:167], v[182:183] neg_lo:[1,0,0] neg_hi:[1,0,0]
    v_pk_fma_f32 v[184:185], v[178:179], v[166:167], v[184:185] neg_lo:[1,0,0] neg_hi:[1,0,0]
    v_pk_fma_f32 v[186:187], v[178:179], v[150:151], v[186:187]
    v_cvt_pk_bf16_f32 v38, v182, v180
    v_cvt_pk_bf16_f32 v54, v186, v184
    v_cvt_pk_bf16_f32 v39, v183, v181
    v_cvt_pk_bf16_f32 v55, v187, v185
    v_mfma_f32_32x32x16_bf16 v[120:135], v[24:27], v[192:195], 0
    v_mfma_f32_32x32x16_bf16 v[104:119], v[24:27], v[208:211], 0
    v_mfma_f32_32x32x16_bf16 v[120:135], v[28:31], v[196:199], v[120:135]
    v_mfma_f32_32x32x16_bf16 v[104:119], v[28:31], v[212:215], v[104:119]
    v_mfma_f32_32x32x16_bf16 v[120:135], v[32:35], v[200:203], v[120:135]
    v_mfma_f32_32x32x16_bf16 v[104:119], v[32:35], v[216:219], v[104:119]
    v_mfma_f32_32x32x16_bf16 v[120:135], v[36:39], v[204:207], v[120:135]
    v_mfma_f32_32x32x16_bf16 v[104:119], v[36:39], v[220:223], v[104:119]
    v_mfma_f32_32x32x16_bf16 v[152:167], v[40:43], v[192:195], 0
    s_nop 10
    v_mul_f32 v168, v104, v224
    v_mul_f32 v169, v120, v224
    v_mul_f32 v170, v105, v225
    v_mul_f32 v171, v121, v225
    v_mul_f32 v172, v106, v226
    v_mul_f32 v173, v122, v226
    v_mul_f32 v174, v107, v227
    v_mul_f32 v175, v123, v227
    v_fma_f32 v168, -v120, v240, v168
    v_fmac_f32 v169, v104, v240
    v_mfma_f32_32x32x16_bf16 v[136:151], v[40:43], v[208:211], 0
    v_fma_f32 v170, -v121, v241, v170
    v_fmac_f32 v171, v105, v241
    v_fma_f32 v172, -v122, v242, v172
    v_fmac_f32 v173, v106, v242
    v_fma_f32 v174, -v123, v243, v174
    v_fmac_f32 v175, v107, v243
    v_cvt_pk_bf16_f32 v24, v169, v168
    v_cvt_pk_bf16_f32 v25, v171, v170
    v_cvt_pk_bf16_f32 v26, v173, v172
    v_cvt_pk_bf16_f32 v27, v175, v174
    v_mfma_f32_32x32x16_bf16 v[152:167], v[44:47], v[196:199], v[152:167]
    v_mul_f32 v168, v108, v228
    v_mul_f32 v169, v124, v228
    v_mul_f32 v170, v109, v229
    v_mul_f32 v171, v125, v229
    v_mul_f32 v172, v110, v230
    v_mul_f32 v173, v126, v230
    v_mul_f32 v174, v111, v231
    v_mul_f32 v175, v127, v231
    v_fma_f32 v168, -v124, v244, v168
    v_fmac_f32 v169, v108, v244
    v_mfma_f32_32x32x16_bf16 v[136:151], v[44:47], v[212:215], v[136:151]
    v_fma_f32 v170, -v125, v245, v170
    v_fmac_f32 v171, v109, v245
    v_fma_f32 v172, -v126, v246, v172
    v_fmac_f32 v173, v110, v246
    v_fma_f32 v174, -v127, v247, v174
    v_fmac_f32 v175, v111, v247
    v_cvt_pk_bf16_f32 v28, v169, v168
    v_cvt_pk_bf16_f32 v29, v171, v170
    v_cvt_pk_bf16_f32 v30, v173, v172
    v_cvt_pk_bf16_f32 v31, v175, v174
    v_mfma_f32_32x32x16_bf16 v[152:167], v[48:51], v[200:203], v[152:167]
    v_mul_f32 v168, v112, v232
    v_mul_f32 v169, v128, v232
    v_mul_f32 v170, v113, v233
    v_mul_f32 v171, v129, v233
    v_mul_f32 v172, v114, v234
    v_mul_f32 v173, v130, v234
    v_mul_f32 v174, v115, v235
    v_mul_f32 v175, v131, v235
    v_fma_f32 v168, -v128, v248, v168
    v_fmac_f32 v169, v112, v248
    v_mfma_f32_32x32x16_bf16 v[136:151], v[48:51], v[216:219], v[136:151]
    v_fma_f32 v170, -v129, v249, v170
    v_fmac_f32 v171, v113, v249
    v_fma_f32 v172, -v130, v250, v172
    v_fmac_f32 v173, v114, v250
    v_fma_f32 v174, -v131, v251, v174
    v_fmac_f32 v175, v115, v251
    v_cvt_pk_bf16_f32 v32, v169, v168
    v_cvt_pk_bf16_f32 v33, v171, v170
    v_cvt_pk_bf16_f32 v34, v173, v172
    v_cvt_pk_bf16_f32 v35, v175, v174
    v_mfma_f32_32x32x16_bf16 v[152:167], v[52:55], v[204:207], v[152:167]
    v_mul_f32 v168, v116, v236
    v_mul_f32 v169, v132, v236
    v_mul_f32 v170, v117, v237
    v_mul_f32 v171, v133, v237
    v_mul_f32 v172, v118, v238
    v_mul_f32 v173, v134, v238
    v_mul_f32 v174, v119, v239
    v_mul_f32 v175, v135, v239
    v_fma_f32 v168, -v132, v252, v168
    v_fmac_f32 v169, v116, v252
    v_mfma_f32_32x32x16_bf16 v[136:151], v[52:55], v[220:223], v[136:151]
    v_fma_f32 v170, -v133, v253, v170
    v_fmac_f32 v171, v117, v253
    v_fma_f32 v172, -v134, v254, v172
    v_fmac_f32 v173, v118, v254
    v_fma_f32 v174, -v135, v255, v174
    v_fmac_f32 v175, v119, v255
    v_cvt_pk_bf16_f32 v36, v169, v168
    v_cvt_pk_bf16_f32 v37, v171, v170
    v_cvt_pk_bf16_f32 v38, v173, v172
    v_cvt_pk_bf16_f32 v39, v175, v174
    v_mfma_f32_32x32x16_bf16 v[120:135], v[192:195], v[24:27], 0
    s_nop 0
    v_mul_f32 v168, v136, v224
    v_mul_f32 v169, v152, v224
    v_mul_f32 v170, v137, v225
    v_mul_f32 v171, v153, v225
    v_mul_f32 v172, v138, v226
    v_mul_f32 v173, v154, v226
    v_mul_f32 v174, v139, v227
    v_mul_f32 v175, v155, v227
    v_fma_f32 v168, -v152, v240, v168
    v_fmac_f32 v169, v136, v240
    v_mfma_f32_32x32x16_bf16 v[104:119], v[208:211], v[24:27], 0
    v_fma_f32 v170, -v153, v241, v170
    v_fmac_f32 v171, v137, v241
    v_fma_f32 v172, -v154, v242, v172
    v_fmac_f32 v173, v138, v242
    v_fma_f32 v174, -v155, v243, v174
    v_fmac_f32 v175, v139, v243
    v_cvt_pk_bf16_f32 v40, v169, v168
    v_cvt_pk_bf16_f32 v41, v171, v170
    v_cvt_pk_bf16_f32 v42, v173, v172
    v_cvt_pk_bf16_f32 v43, v175, v174
    v_mfma_f32_32x32x16_bf16 v[120:135], v[196:199], v[28:31], v[120:135]
    v_mul_f32 v168, v140, v228
    v_mul_f32 v169, v156, v228
    v_mul_f32 v170, v141, v229
    v_mul_f32 v171, v157, v229
    v_mul_f32 v172, v142, v230
    v_mul_f32 v173, v158, v230
    v_mul_f32 v174, v143, v231
    v_mul_f32 v175, v159, v231
    v_fma_f32 v168, -v156, v244, v168
    v_fmac_f32 v169, v140, v244
    v_mfma_f32_32x32x16_bf16 v[104:119], v[212:215], v[28:31], v[104:119]
    v_fma_f32 v170, -v157, v245, v170
    v_fmac_f32 v171, v141, v245
    v_fma_f32 v172, -v158, v246, v172
    v_fmac_f32 v173, v142, v246
    v_fma_f32 v174, -v159, v247, v174
    v_fmac_f32 v175, v143, v247
    v_cvt_pk_bf16_f32 v44, v169, v168
    v_cvt_pk_bf16_f32 v45, v171, v170
    v_cvt_pk_bf16_f32 v46, v173, v172
    v_cvt_pk_bf16_f32 v47, v175, v174
    v_mfma_f32_32x32x16_bf16 v[120:135], v[200:203], v[32:35], v[120:135]
    v_mul_f32 v168, v144, v232
    v_mul_f32 v169, v160, v232
    v_mul_f32 v170, v145, v233
    v_mul_f32 v171, v161, v233
    v_mul_f32 v172, v146, v234
    v_mul_f32 v173, v162, v234
    v_mul_f32 v174, v147, v235
    v_mul_f32 v175, v163, v235
    v_fma_f32 v168, -v160, v248, v168
    v_fmac_f32 v169, v144, v248
    v_mfma_f32_32x32x16_bf16 v[104:119], v[216:219], v[32:35], v[104:119]
    v_fma_f32 v170, -v161, v249, v170
    v_fmac_f32 v171, v145, v249
    v_fma_f32 v172, -v162, v250, v172
    v_fmac_f32 v173, v146, v250
    v_fma_f32 v174, -v163, v251, v174
    v_fmac_f32 v175, v147, v251
    v_cvt_pk_bf16_f32 v48, v169, v168
    v_cvt_pk_bf16_f32 v49, v171, v170
    v_cvt_pk_bf16_f32 v50, v173, v172
    v_cvt_pk_bf16_f32 v51, v175, v174
    v_mfma_f32_32x32x16_bf16 v[120:135], v[204:207], v[36:39], v[120:135]
    v_mul_f32 v168, v148, v236
    v_mul_f32 v169, v164, v236
    v_mul_f32 v170, v149, v237
    v_mul_f32 v171, v165, v237
    v_mul_f32 v172, v150, v238
    v_mul_f32 v173, v166, v238
    v_mul_f32 v174, v151, v239
    v_mul_f32 v175, v167, v239
    v_fma_f32 v168, -v164, v252, v168
    v_fmac_f32 v169, v148, v252
    v_mfma_f32_32x32x16_bf16 v[104:119], v[220:223], v[36:39], v[104:119]
    v_fma_f32 v170, -v165, v253, v170
    v_fmac_f32 v171, v149, v253
    v_fma_f32 v172, -v166, v254, v172
    v_fmac_f32 v173, v150, v254
    v_fma_f32 v174, -v167, v255, v174
    v_fmac_f32 v175, v151, v255
    v_cvt_pk_bf16_f32 v52, v169, v168
    v_cvt_pk_bf16_f32 v53, v171, v170
    v_cvt_pk_bf16_f32 v54, v173, v172
    v_cvt_pk_bf16_f32 v55, v175, v174
    s_mul_i32 s53, s52, 8448
    s_cmp_eq_u32 s52, 320
    s_cselect_b32 s53, 4224, s53
    s_add_u32 s53, s53, 6340608
    s_add_u32 s54, s53, 4224
    s_cmp_lg_u32 s58, 0
    s_cbranch_scc1 L_73
    v_mfma_f32_32x32x16_bf16 v[152:167], v[192:195], v[40:43], 0
    v_cvt_pk_bf16_f32 v24, v120, v104
    v_cvt_pk_bf16_f32 v25, v121, v105
    v_mfma_f32_32x32x16_bf16 v[136:151], v[208:211], v[40:43], 0
    v_cvt_pk_bf16_f32 v26, v122, v106
    v_cvt_pk_bf16_f32 v27, v123, v107
    buffer_store_dwordx4 v[24:27], v18, s[12:15], s53 offen offset:0 sc1
    v_mfma_f32_32x32x16_bf16 v[152:167], v[196:199], v[44:47], v[152:167]
    v_cvt_pk_bf16_f32 v28, v124, v108
    v_cvt_pk_bf16_f32 v29, v125, v109
    v_mfma_f32_32x32x16_bf16 v[136:151], v[212:215], v[44:47], v[136:151]
    v_cvt_pk_bf16_f32 v30, v126, v110
    v_cvt_pk_bf16_f32 v31, v127, v111
    buffer_store_dwordx4 v[28:31], v18, s[12:15], s53 offen offset:1024 sc1
    v_mfma_f32_32x32x16_bf16 v[152:167], v[200:203], v[48:51], v[152:167]
    v_cvt_pk_bf16_f32 v32, v128, v112
    v_cvt_pk_bf16_f32 v33, v129, v113
    v_mfma_f32_32x32x16_bf16 v[136:151], v[216:219], v[48:51], v[136:151]
    v_cvt_pk_bf16_f32 v34, v130, v114
    v_cvt_pk_bf16_f32 v35, v131, v115
    buffer_store_dwordx4 v[32:35], v18, s[12:15], s53 offen offset:2048 sc1
    v_mfma_f32_32x32x16_bf16 v[152:167], v[204:207], v[52:55], v[152:167]
    v_cvt_pk_bf16_f32 v36, v132, v116
    v_cvt_pk_bf16_f32 v37, v133, v117
    v_mfma_f32_32x32x16_bf16 v[136:151], v[220:223], v[52:55], v[136:151]
    v_cvt_pk_bf16_f32 v38, v134, v118
    v_cvt_pk_bf16_f32 v39, v135, v119
    buffer_store_dwordx4 v[36:39], v18, s[12:15], s53 offen offset:3072 sc1
    s_nop 8
    v_cvt_pk_bf16_f32 v56, -v152, v136
    v_cvt_pk_bf16_f32 v57, -v153, v137
    v_cvt_pk_bf16_f32 v58, -v154, v138
    v_cvt_pk_bf16_f32 v59, -v155, v139
    buffer_store_dwordx4 v[56:59], v18, s[12:15], s54 offen offset:0 sc1
    v_cvt_pk_bf16_f32 v60, -v156, v140
    v_cvt_pk_bf16_f32 v61, -v157, v141
    v_cvt_pk_bf16_f32 v62, -v158, v142
    v_cvt_pk_bf16_f32 v63, -v159, v143
    buffer_store_dwordx4 v[60:63], v18, s[12:15], s54 offen offset:1024 sc1
    v_cvt_pk_bf16_f32 v64, -v160, v144
    v_cvt_pk_bf16_f32 v65, -v161, v145
    v_cvt_pk_bf16_f32 v66, -v162, v146
    v_cvt_pk_bf16_f32 v67, -v163, v147
    buffer_store_dwordx4 v[64:67], v18, s[12:15], s54 offen offset:2048 sc1
    v_cvt_pk_bf16_f32 v68, -v164, v148
    v_cvt_pk_bf16_f32 v69, -v165, v149
    v_cvt_pk_bf16_f32 v70, -v166, v150
    v_cvt_pk_bf16_f32 v71, -v167, v151
    buffer_store_dwordx4 v[68:71], v18, s[12:15], s54 offen offset:3072 sc1
L_74:
L_f2end:
    s_waitcnt vmcnt(0)
    s_barrier
    s_cmp_lt_u32 s3, 4
    s_cbranch_scc1 L_fin
    s_call_b64 s[38:39], L_consts
    s_branch L_fin
L_73:
    s_nop 3
    v_mfma_f32_32x32x16_bf16 v[152:167], v[192:195], v[40:43], 0
    v_mfma_f32_32x32x16_bf16 v[136:151], v[208:211], v[40:43], 0
    v_mfma_f32_32x32x16_bf16 v[152:167], v[196:199], v[44:47], v[152:167]
    v_mfma_f32_32x32x16_bf16 v[136:151], v[212:215], v[44:47], v[136:151]
    v_mfma_f32_32x32x16_bf16 v[152:167], v[200:203], v[48:51], v[152:167]
    v_mfma_f32_32x32x16_bf16 v[136:151], v[216:219], v[48:51], v[136:151]
    v_mfma_f32_32x32x16_bf16 v[152:167], v[204:207], v[52:55], v[152:167]
    v_mfma_f32_32x32x16_bf16 v[136:151], v[220:223], v[52:55], v[136:151]
    s_nop 11
    v_add_f32 v104, v104, v136
    v_sub_f32 v120, v120, v152
    v_mul_f32 v104, 0.5, v104
    v_mul_f32 v120, 0.5, v120
    v_add_f32 v105, v105, v137
    v_sub_f32 v121, v121, v153
    v_mul_f32 v105, 0.5, v105
    v_mul_f32 v121, 0.5, v121
    v_add_f32 v106, v106, v138
    v_sub_f32 v122, v122, v154
    v_mul_f32 v106, 0.5, v106
    v_mul_f32 v122, 0.5, v122
    v_add_f32 v107, v107, v139
    v_sub_f32 v123, v123, v155
    v_mul_f32 v107, 0.5, v107
    v_mul_f32 v123, 0.5, v123
    v_add_f32 v108, v108, v140
    v_sub_f32 v124, v124, v156
    v_mul_f32 v108, 0.5, v108
    v_mul_f32 v124, 0.5, v124
    v_add_f32 v109, v109, v141
    v_sub_f32 v125, v125, v157
    v_mul_f32 v109, 0.5, v109
    v_mul_f32 v125, 0.5, v125
    v_add_f32 v110, v110, v142
    v_sub_f32 v126, v126, v158
    v_mul_f32 v110, 0.5, v110
    v_mul_f32 v126, 0.5, v126
    v_add_f32 v111, v111, v143
    v_sub_f32 v127, v127, v159
    v_mul_f32 v111, 0.5, v111
    v_mul_f32 v127, 0.5, v127
    v_add_f32 v112, v112, v144
    v_sub_f32 v128, v128, v160
    v_mul_f32 v112, 0.5, v112
    v_mul_f32 v128, 0.5, v128
    v_add_f32 v113, v113, v145
    v_sub_f32 v129, v129, v161
    v_mul_f32 v113, 0.5, v113
    v_mul_f32 v129, 0.5, v129
    v_add_f32 v114, v114, v146
    v_sub_f32 v130, v130, v162
    v_mul_f32 v114, 0.5, v114
    v_mul_f32 v130, 0.5, v130
    v_add_f32 v115, v115, v147
    v_sub_f32 v131, v131, v163
    v_mul_f32 v115, 0.5, v115
    v_mul_f32 v131, 0.5, v131
    v_add_f32 v116, v116, v148
    v_sub_f32 v132, v132, v164
    v_mul_f32 v116, 0.5, v116
    v_mul_f32 v132, 0.5, v132
    v_add_f32 v117, v117, v149
    v_sub_f32 v133, v133, v165
    v_mul_f32 v117, 0.5, v117
    v_mul_f32 v133, 0.5, v133
    v_add_f32 v118, v118, v150
    v_sub_f32 v134, v134, v166
    v_mul_f32 v118, 0.5, v118
    v_mul_f32 v134, 0.5, v134
    v_add_f32 v119, v119, v151
    v_sub_f32 v135, v135, v167
    v_mul_f32 v119, 0.5, v119
    v_mul_f32 v135, 0.5, v135
    v_cvt_pk_bf16_f32 v24, v120, v104
    v_cvt_pk_bf16_f32 v25, v121, v105
    v_cvt_pk_bf16_f32 v26, v122, v106
    v_cvt_pk_bf16_f32 v27, v123, v107
    buffer_store_dwordx4 v[24:27], v18, s[12:15], s53 offen offset:0 sc1
    v_cvt_pk_bf16_f32 v28, v124, v108
    v_cvt_pk_bf16_f32 v29, v125, v109
    v_cvt_pk_bf16_f32 v30, v126, v110
    v_cvt_pk_bf16_f32 v31, v127, v111
    buffer_store_dwordx4 v[28:31], v18, s[12:15], s53 offen offset:1024 sc1
    v_cvt_pk_bf16_f32 v32, v128, v112
    v_cvt_pk_bf16_f32 v33, v129, v113
    v_cvt_pk_bf16_f32 v34, v130, v114
    v_cvt_pk_bf16_f32 v35, v131, v115
    buffer_store_dwordx4 v[32:35], v18, s[12:15], s53 offen offset:2048 sc1
    v_cvt_pk_bf16_f32 v36, v132, v116
    v_cvt_pk_bf16_f32 v37, v133, v117
    v_cvt_pk_bf16_f32 v38, v134, v118
    v_cvt_pk_bf16_f32 v39, v135, v119
    buffer_store_dwordx4 v[36:39], v18, s[12:15], s53 offen offset:3072 sc1
    s_branch L_74
L_idle:
    s_cmp_lg_u32 s3, 7
    s_cbranch_scc1 L_75
    s_lshl_b32 s48, s44, 3
    v_lshlrev_b32 v21, 9, v2
    v_add_u32 v21, s48, v21
    s_lshl_b32 s49, s44, 9
    s_add_u32 s49, s49, 25100288
    v_lshlrev_b32 v22, 3, v1
    s_mov_b32 s48, 25083904
    s_barrier
    v_mov_b32 v14, s6
    v_mov_b32 v15, s7
    s_mov_b64 exec, 0xffffffff
    buffer_store_dwordx2 v[14:15], v21, s[12:15], s48 offen offset:0 sc1
    s_mov_b64 exec, -1
    buffer_store_dwordx2 v[14:15], v22, s[12:15], s49 offen sc1
    s_branch L_fin
L_75:
    s_barrier
L_fin:
    s_nop 7
    s_setprio 0
    s_mov_b32 s8, s64
    s_and_b32 s9, s65, 0xffff
    s_mov_b32 s10, 0x280000
    s_mov_b32 s11, 0x00020000
    s_mov_b32 s24, s80
    s_and_b32 s25, s81, 0xffff
    s_mov_b32 s26, 0x280000
    s_mov_b32 s27, 0x00020000
    s_mov_b32 s20, s78
    s_and_b32 s21, s79, 0xffff
    s_mov_b32 s22, 0x500
    s_mov_b32 s23, 0x00020000
    s_lshl_b32 s53, s43, 2
    s_lshr_b32 s53, 0x1234567, s53
    s_and_b32 s53, s53, 7
    s_cmp_eq_u32 s53, 0
    s_cselect_b32 s54, 20480, 0
    s_mul_i32 s53, s53, 20480
    s_lshr_b32 s44, s3, 2
    s_lshl_b32 s44, s44, 6
    s_add_u32 s44, s44, 512
    v_add_u32 v8, s44, v1
    v_lshlrev_b32 v21, 1, v0
    v_lshlrev_b32 v22, 1, v8
    v_lshlrev_b32 v19, 4, v0
    s_and_b32 s51, s3, 3
    s_lshl_b32 s44, s51, 2
    v_lshlrev_b32 v20, 4, v8
    v_add_u32 v20, s44, v20
    v_mul_u32_u24 v9, 3277, v0
    v_lshrrev_b32 v9, 16, v9
    v_lshl_add_u32 v17, v9, 4, v19
    v_mul_u32_u24 v9, 3277, v8
    v_lshrrev_b32 v9, 16, v9
    v_lshl_add_u32 v18, v9, 4, v20
    v_add_u32 v17, s54, v17
    v_add_u32 v18, s54, v18
    s_lshl_b32 s47, s42, 8
    s_lshl_b32 s44, s5, 1
    s_add_u32 s47, s47, s44
    s_mul_i32 s47, s47, 1280
    s_mul_i32 s51, s51, 81920
    s_add_u32 s51, s51, s47
    s_mul_i32 s48, s41, 10240
    s_add_u32 s48, s48, 16908288
    s_lshr_b32 s52, s41, 2
    s_lshl_b32 s52, s52, 11
    s_add_u32 s52, s52, 25329664
    v_lshlrev_b32 v15, 7, v1
    s_cmp_eq_u32 s3, 7
    s_cbranch_scc1 L_76
    s_add_u32 s44, s47, 0
    buffer_load_short_d16_hi v26, v21, s[8:11], s44 offen offset:0
    buffer_load_short_d16_hi v27, v21, s[8:11], s44 offen offset:1280
    s_add_u32 s44, s47, 81920
    buffer_load_short_d16_hi v28, v21, s[8:11], s44 offen offset:0
    buffer_load_short_d16_hi v29, v21, s[8:11], s44 offen offset:1280
    s_add_u32 s44, s47, 163840
    buffer_load_short_d16_hi v30, v21, s[8:11], s44 offen offset:0
    buffer_load_short_d16_hi v31, v21, s[8:11], s44 offen offset:1280
    s_add_u32 s44, s47, 245760
    buffer_load_short_d16_hi v32, v21, s[8:11], s44 offen offset:0
    buffer_load_short_d16_hi v33, v21, s[8:11], s44 offen offset:1280
    buffer_load_short_d16_hi v34, v22, s[8:11], s51 offen offset:0
    buffer_load_short_d16_hi v35, v22, s[8:11], s51 offen offset:1280
    buffer_load_short_d16_hi v36, v21, s[20:23], 0 offen
    buffer_load_short_d16_hi v37, v22, s[20:23], 0 offen
L_76:
    s_cmp_lt_u32 s3, 4
    s_cbranch_scc1 L_77
    s_lshl_b32 s45, s41, 4
    s_add_u32 s45, s45, 6340608
    s_and_b32 s49, s3, 3
    v_mov_b32 v94, 0
    v_mov_b32 v95, 0
    s_lshl_b32 s44, s49, 2
    v_lshlrev_b32 v14, 4, v1
    v_add_u32 v14, s44, v14
    v_add_u32 v14, s53, v14
    v_mul_u32_u24 v16, 336, v2
    v_mul_u32_u24 v8, 160, v3
    v_add3_u32 v16, v16, v8, s44
    v_add_u32 v16, s54, v16
    s_cmp_lg_u32 s3, 7
    s_cbranch_scc1 L_79
    v_sub_u32 v9, 320, v2
    v_cmp_eq_u32 vcc, 1, v3
    s_nop 1
    v_cndmask_b32 v10, v2, v9, vcc
    v_lshl_add_u32 v10, v10, 1, v3
    v_mul_u32_u24 v10, 4224, v10
    v_mov_b32 v11, 270336
    v_mov_b32 v12, 4294696960
    v_cndmask_b32 v11, v11, v12, vcc
    v_cmp_ne_u32 vcc, 2707584, v10
    v_mov_b32 v12, 4224
    s_nop 0
    v_cndmask_b32 v12, v12, v10, vcc
    s_lshl_b32 s50, s2, 7
    s_add_u32 s50, s50, 25100288
    v_lshlrev_b32 v13, 3, v1
    s_mov_b64 exec, 1
    s_mov_b32 s40, 0
poll_80:
    buffer_load_dwordx2 v[24:25], v13, s[12:15], s50 offen offset:0 sc1
pollc_82:
    s_waitcnt vmcnt(0)
    v_cmp_ne_u64 vcc, s[6:7], v[24:25]
    s_add_u32 s40, s40, 1
    s_cbranch_vccz pollx_81
    s_sleep 12
    s_cmp_lt_u32 s40, 400000
    s_cbranch_scc1 poll_80
pollx_81:
    s_mov_b64 exec, -1
    s_and_b32 s50, s2, 31
    s_lshl_b32 s50, s50, 9
    s_add_u32 s50, s50, 25083904
    s_mov_b32 s40, 0
poll_83:
    buffer_load_dwordx2 v[24:25], v13, s[12:15], s50 offen offset:0 sc1
pollc_85:
    s_waitcnt vmcnt(0)
    v_cmp_ne_u64 vcc, s[6:7], v[24:25]
    s_add_u32 s40, s40, 1
    s_cbranch_vccz pollx_84
    s_sleep 6
    s_cmp_lt_u32 s40, 400000
    s_cbranch_scc1 poll_83
pollx_84:
    s_mov_b32 m0, s53
    s_nop 0
    buffer_load_dwordx4 v12, s[12:15], s45 offen sc1 lds
    v_add_u32 v10, v10, v11
    s_add_u32 m0, m0, 1024
    s_nop 0
    buffer_load_dwordx4 v10, s[12:15], s45 offen sc1 lds
    v_add_u32 v10, v10, v11
    s_add_u32 m0, m0, 1024
    s_nop 0
    buffer_load_dwordx4 v10, s[12:15], s45 offen sc1 lds
    v_add_u32 v10, v10, v11
    s_add_u32 m0, m0, 1024
    s_nop 0
    buffer_load_dwordx4 v10, s[12:15], s45 offen sc1 lds
    v_add_u32 v10, v10, v11
    s_add_u32 m0, m0, 1024
    s_nop 0
    buffer_load_dwordx4 v10, s[12:15], s45 offen sc1 lds
    v_add_u32 v10, v10, v11
    s_add_u32 m0, m0, 1024
    s_nop 0
    buffer_load_dwordx4 v10, s[12:15], s45 offen sc1 lds
    v_add_u32 v10, v10, v11
    s_add_u32 m0, m0, 1024
    s_nop 0
    buffer_load_dwordx4 v10, s[12:15], s45 offen sc1 lds
    v_add_u32 v10, v10, v11
    s_add_u32 m0, m0, 1024
    s_nop 0
    buffer_load_dwordx4 v10, s[12:15], s45 offen sc1 lds
    v_add_u32 v10, v10, v11
    s_add_u32 m0, m0, 1024
    s_nop 0
    buffer_load_dwordx4 v10, s[12:15], s45 offen sc1 lds
    v_add_u32 v10, v10, v11
    s_add_u32 m0, m0, 1024
    s_nop 0
    buffer_load_dwordx4 v10, s[12:15], s45 offen sc1 lds
    s_add_u32 s44, s47, 0
    buffer_load_short_d16_hi v26, v21, s[8:11], s44 offen offset:0
    buffer_load_short_d16_hi v27, v21, s[8:11], s44 offen offset:1280
    s_add_u32 s44, s47, 81920
    buffer_load_short_d16_hi v28, v21, s[8:11], s44 offen offset:0
    buffer_load_short_d16_hi v29, v21, s[8:11], s44 offen offset:1280
    s_add_u32 s44, s47, 163840
    buffer_load_short_d16_hi v30, v21, s[8:11], s44 offen offset:0
    buffer_load_short_d16_hi v31, v21, s[8:11], s44 offen offset:1280
    s_add_u32 s44, s47, 245760
    buffer_load_short_d16_hi v32, v21, s[8:11], s44 offen offset:0
    buffer_load_short_d16_hi v33, v21, s[8:11], s44 offen offset:1280
    buffer_load_short_d16_hi v34, v22, s[8:11], s51 offen offset:0
    buffer_load_short_d16_hi v35, v22, s[8:11], s51 offen offset:1280
    buffer_load_short_d16_hi v36, v21, s[20:23], 0 offen
    buffer_load_short_d16_hi v37, v22, s[20:23], 0 offen
    s_waitcnt vmcnt(12)
L_79:
    s_barrier
    ds_read_b32 v84, v14 offset:0
    ds_read_b32 v85, v14 offset:1024
    ds_read_b32 v86, v14 offset:2048
    ds_read_b32 v87, v14 offset:3072
    ds_read_b32 v88, v14 offset:4096
    ds_read_b32 v89, v14 offset:5120
    ds_read_b32 v90, v14 offset:6144
    ds_read_b32 v91, v14 offset:7168
    ds_read_b32 v92, v14 offset:8192
    ds_read_b32 v93, v14 offset:9216
    s_waitcnt lgkmcnt(0)
    v_mfma_f32_32x32x16_bf16 v[112:127], v[84:87], v[168:171], 0
    v_mfma_f32_32x32x16_bf16 v[96:111], v[84:87], v[180:183], 0
    v_mfma_f32_32x32x16_bf16 v[112:127], v[88:91], v[172:175], v[112:127]
    v_mfma_f32_32x32x16_bf16 v[96:111], v[88:91], v[184:187], v[96:111]
    v_mfma_f32_32x32x16_bf16 v[112:127], v[92:95], v[176:179], v[112:127]
    v_mfma_f32_32x32x16_bf16 v[96:111], v[92:95], v[188:191], v[96:111]
    s_nop 11
    v_pk_mul_f32 v[72:73], v[96:97], v[224:225]
    v_pk_mul_f32 v[74:75], v[112:113], v[224:225]
    v_pk_mul_f32 v[76:77], v[98:99], v[226:227]
    v_pk_mul_f32 v[78:79], v[114:115], v[226:227]
    v_pk_fma_f32 v[72:73], v[112:113], v[240:241], v[72:73] neg_lo:[1,0,0] neg_hi:[1,0,0]
    v_pk_fma_f32 v[74:75], v[96:97], v[240:241], v[74:75]
    v_pk_fma_f32 v[76:77], v[114:115], v[242:243], v[76:77] neg_lo:[1,0,0] neg_hi:[1,0,0]
    v_pk_fma_f32 v[78:79], v[98:99], v[242:243], v[78:79]
    v_cvt_pk_bf16_f32 v128, v74, v72
    v_cvt_pk_bf16_f32 v129, v75, v73
    v_cvt_pk_bf16_f32 v130, v78, v76
    v_cvt_pk_bf16_f32 v131, v79, v77
    v_pk_mul_f32 v[72:73], v[100:101], v[228:229]
    v_pk_mul_f32 v[74:75], v[116:117], v[228:229]
    v_pk_mul_f32 v[76:77], v[102:103], v[230:231]
    v_pk_mul_f32 v[78:79], v[118:119], v[230:231]
    v_pk_fma_f32 v[72:73], v[116:117], v[244:245], v[72:73] neg_lo:[1,0,0] neg_hi:[1,0,0]
    v_pk_fma_f32 v[74:75], v[100:101], v[244:245], v[74:75]
    v_pk_fma_f32 v[76:77], v[118:119], v[246:247], v[76:77] neg_lo:[1,0,0] neg_hi:[1,0,0]
    v_pk_fma_f32 v[78:79], v[102:103], v[246:247], v[78:79]
    v_cvt_pk_bf16_f32 v132, v74, v72
    v_cvt_pk_bf16_f32 v133, v75, v73
    v_cvt_pk_bf16_f32 v134, v78, v76
    v_cvt_pk_bf16_f32 v135, v79, v77
    v_pk_mul_f32 v[72:73], v[104:105], v[232:233]
    v_pk_mul_f32 v[74:75], v[120:121], v[232:233]
    v_pk_mul_f32 v[76:77], v[106:107], v[234:235]
    v_pk_mul_f32 v[78:79], v[122:123], v[234:235]
    v_pk_fma_f32 v[72:73], v[120:121], v[248:249], v[72:73] neg_lo:[1,0,0] neg_hi:[1,0,0]
    v_pk_fma_f32 v[74:75], v[104:105], v[248:249], v[74:75]
    v_pk_fma_f32 v[76:77], v[122:123], v[250:251], v[76:77] neg_lo:[1,0,0] neg_hi:[1,0,0]
    v_pk_fma_f32 v[78:79], v[106:107], v[250:251], v[78:79]
    v_cvt_pk_bf16_f32 v136, v74, v72
    v_cvt_pk_bf16_f32 v137, v75, v73
    v_cvt_pk_bf16_f32 v138, v78, v76
    v_cvt_pk_bf16_f32 v139, v79, v77
    v_pk_mul_f32 v[72:73], v[108:109], v[236:237]
    v_pk_mul_f32 v[74:75], v[124:125], v[236:237]
    v_pk_mul_f32 v[76:77], v[110:111], v[238:239]
    v_pk_mul_f32 v[78:79], v[126:127], v[238:239]
    v_pk_fma_f32 v[72:73], v[124:125], v[252:253], v[72:73] neg_lo:[1,0,0] neg_hi:[1,0,0]
    v_pk_fma_f32 v[74:75], v[108:109], v[252:253], v[74:75]
    v_pk_fma_f32 v[76:77], v[126:127], v[254:255], v[76:77] neg_lo:[1,0,0] neg_hi:[1,0,0]
    v_pk_fma_f32 v[78:79], v[110:111], v[254:255], v[78:79]
    v_cvt_pk_bf16_f32 v140, v74, v72
    v_cvt_pk_bf16_f32 v141, v75, v73
    v_cvt_pk_bf16_f32 v142, v78, v76
    v_cvt_pk_bf16_f32 v143, v79, v77
    v_mfma_f32_32x32x16_bf16 v[112:127], v[128:131], v[192:195], 0
    v_mfma_f32_32x32x16_bf16 v[96:111], v[128:131], v[208:211], 0
    v_mfma_f32_32x32x16_bf16 v[112:127], v[132:135], v[196:199], v[112:127]
    v_mfma_f32_32x32x16_bf16 v[96:111], v[132:135], v[212:215], v[96:111]
    v_mfma_f32_32x32x16_bf16 v[112:127], v[136:139], v[200:203], v[112:127]
    v_mfma_f32_32x32x16_bf16 v[96:111], v[136:139], v[216:219], v[96:111]
    v_mfma_f32_32x32x16_bf16 v[112:127], v[140:143], v[204:207], v[112:127]
    v_mfma_f32_32x32x16_bf16 v[96:111], v[140:143], v[220:223], v[96:111]
    s_nop 11
    v_cvt_pk_bf16_f32 v84, v96, v112
    ds_write_b32 v16, v84 offset:0
    v_cvt_pk_bf16_f32 v85, v97, v113
    ds_write_b32 v16, v85 offset:16
    v_cvt_pk_bf16_f32 v86, v98, v114
    ds_write_b32 v16, v86 offset:32
    v_cvt_pk_bf16_f32 v87, v99, v115
    ds_write_b32 v16, v87 offset:48
    v_cvt_pk_bf16_f32 v88, v100, v116
    ds_write_b32 v16, v88 offset:64
    v_cvt_pk_bf16_f32 v89, v101, v117
    ds_write_b32 v16, v89 offset:80
    v_cvt_pk_bf16_f32 v90, v102, v118
    ds_write_b32 v16, v90 offset:96
    v_cvt_pk_bf16_f32 v91, v103, v119
    ds_write_b32 v16, v91 offset:112
    v_cvt_pk_bf16_f32 v92, v104, v120
    ds_write_b32 v16, v92 offset:128
    v_cvt_pk_bf16_f32 v93, v105, v121
    ds_write_b32 v16, v93 offset:144
    s_branch L_78
L_77:
    s_barrier
    s_cmp_lg_u32 s3, 0
    s_cbranch_scc1 L_78
    s_mov_b64 exec, 0xfff
    s_mov_b32 s40, 0
poll_86:
    buffer_load_dwordx2 v[24:25], v15, s[12:15], s52 offen offset:0 sc1
pollc_88:
    s_waitcnt vmcnt(0)
    v_cmp_ne_u64 vcc, s[6:7], v[24:25]
    s_add_u32 s40, s40, 1
    s_cbranch_vccz pollx_87
    s_sleep 2
    s_cmp_lt_u32 s40, 400000
    s_cbranch_scc1 poll_86
pollx_87:
    s_mov_b64 exec, -1
L_78:
    s_waitcnt lgkmcnt(0)
    s_barrier
    s_add_u32 s44, s48, 0
    buffer_load_dwordx4 v[40:43], v19, s[12:15], s44 offen sc1
    buffer_load_dword v52, v20, s[12:15], s44 offen sc1
    s_add_u32 s44, s48, 2621440
    buffer_load_dwordx4 v[44:47], v19, s[12:15], s44 offen sc1
    buffer_load_dword v53, v20, s[12:15], s44 offen sc1
    s_add_u32 s44, s48, 5242880
    buffer_load_dwordx4 v[48:51], v19, s[12:15], s44 offen sc1
    buffer_load_dword v54, v20, s[12:15], s44 offen sc1
    s_mov_b32 s49, 0x00003f80
    s_mov_b32 s50, 0x3f800000
    v_mov_b32 v8, 0x49a00000
    s_waitcnt vmcnt(6)
    v_mov_b32 v62, v36
    v_mov_b32 v63, v36
    v_mov_b32 v64, v36
    v_mov_b32 v65, v36
    v_mov_b32 v66, v36
    v_mov_b32 v67, v36
    v_mov_b32 v68, v36
    v_mov_b32 v69, v36
    v_mov_b32 v70, v37
    v_mov_b32 v71, v37
    ds_read_b128 v[56:59], v17
    ds_read_b32 v60, v18
    s_waitcnt vmcnt(4)
    v_dot2c_f32_bf16 v62, s49, v40
    v_dot2c_f32_bf16 v63, s50, v40
    v_dot2c_f32_bf16 v64, s49, v41
    v_dot2c_f32_bf16 v65, s50, v41
    v_dot2c_f32_bf16 v66, s49, v42
    v_dot2c_f32_bf16 v67, s50, v42
    v_dot2c_f32_bf16 v68, s49, v43
    v_dot2c_f32_bf16 v69, s50, v43
    v_dot2c_f32_bf16 v70, s49, v52
    v_dot2c_f32_bf16 v71, s50, v52
    s_waitcnt vmcnt(2)
    v_dot2c_f32_bf16 v62, s49, v44
    v_dot2c_f32_bf16 v63, s50, v44
    v_dot2c_f32_bf16 v64, s49, v45
    v_dot2c_f32_bf16 v65, s50, v45
    v_dot2c_f32_bf16 v66, s49, v46
    v_dot2c_f32_bf16 v67, s50, v46
    v_dot2c_f32_bf16 v68, s49, v47
    v_dot2c_f32_bf16 v69, s50, v47
    v_dot2c_f32_bf16 v70, s49, v53
    v_dot2c_f32_bf16 v71, s50, v53
    s_waitcnt vmcnt(0)
    v_dot2c_f32_bf16 v62, s49, v48
    v_dot2c_f32_bf16 v63, s50, v48
    v_dot2c_f32_bf16 v64, s49, v49
    v_dot2c_f32_bf16 v65, s50, v49
    v_dot2c_f32_bf16 v66, s49, v50
    v_dot2c_f32_bf16 v67, s50, v50
    v_dot2c_f32_bf16 v68, s49, v51
    v_dot2c_f32_bf16 v69, s50, v51
    v_dot2c_f32_bf16 v70, s49, v54
    v_dot2c_f32_bf16 v71, s50, v54
    v_mul_f32 v72, 0xbfb8aa3b, v62
    v_mul_f32 v73, 0xbfb8aa3b, v63
    v_mul_f32 v74, 0xbfb8aa3b, v64
    v_mul_f32 v75, 0xbfb8aa3b, v65
    v_mul_f32 v76, 0xbfb8aa3b, v66
    v_mul_f32 v77, 0xbfb8aa3b, v67
    v_mul_f32 v78, 0xbfb8aa3b, v68
    v_mul_f32 v79, 0xbfb8aa3b, v69
    v_mul_f32 v80, 0xbfb8aa3b, v70
    v_mul_f32 v81, 0xbfb8aa3b, v71
    v_exp_f32 v72, v72
    v_exp_f32 v73, v73
    v_exp_f32 v74, v74
    v_exp_f32 v75, v75
    v_exp_f32 v76, v76
    v_exp_f32 v77, v77
    v_exp_f32 v78, v78
    v_exp_f32 v79, v79
    v_exp_f32 v80, v80
    v_exp_f32 v81, v81
    v_fma_f32 v72, v72, v8, v8
    v_fma_f32 v73, v73, v8, v8
    v_fma_f32 v74, v74, v8, v8
    v_fma_f32 v75, v75, v8, v8
    v_fma_f32 v76, v76, v8, v8
    v_fma_f32 v77, v77, v8, v8
    v_fma_f32 v78, v78, v8, v8
    v_fma_f32 v79, v79, v8, v8
    v_fma_f32 v80, v80, v8, v8
    v_fma_f32 v81, v81, v8, v8
    v_rcp_f32 v72, v72
    v_rcp_f32 v73, v73
    v_rcp_f32 v74, v74
    v_rcp_f32 v75, v75
    v_rcp_f32 v76, v76
    v_rcp_f32 v77, v77
    v_rcp_f32 v78, v78
    v_rcp_f32 v79, v79
    v_rcp_f32 v80, v80
    v_rcp_f32 v81, v81
    v_mul_f32 v62, v62, v72
    v_mul_f32 v63, v63, v73
    v_mul_f32 v64, v64, v74
    v_mul_f32 v65, v65, v75
    v_mul_f32 v66, v66, v76
    v_mul_f32 v67, v67, v77
    v_mul_f32 v68, v68, v78
    v_mul_f32 v69, v69, v79
    v_mul_f32 v70, v70, v80
    v_mul_f32 v71, v71, v81
    s_waitcnt lgkmcnt(0)
    v_lshlrev_b32 v72, 16, v56
    v_and_b32 v73, 0xffff0000, v56
    v_lshlrev_b32 v74, 16, v57
    v_and_b32 v75, 0xffff0000, v57
    v_lshlrev_b32 v76, 16, v58
    v_and_b32 v77, 0xffff0000, v58
    v_lshlrev_b32 v78, 16, v59
    v_and_b32 v79, 0xffff0000, v59
    v_lshlrev_b32 v80, 16, v60
    v_and_b32 v81, 0xffff0000, v60
    v_fmac_f32 v26, v72, v62
    v_fmac_f32 v27, v73, v63
    v_cvt_pk_bf16_f32 v62, v26, v27
    s_add_u32 s44, s47, 0
    buffer_store_short v62, v21, s[24:27], s44 offen
    buffer_store_short_d16_hi v62, v21, s[24:27], s44 offen offset:1280
    v_fmac_f32 v28, v74, v64
    v_fmac_f32 v29, v75, v65
    v_cvt_pk_bf16_f32 v64, v28, v29
    s_add_u32 s44, s47, 81920
    buffer_store_short v64, v21, s[24:27], s44 offen
    buffer_store_short_d16_hi v64, v21, s[24:27], s44 offen offset:1280
    v_fmac_f32 v30, v76, v66
    v_fmac_f32 v31, v77, v67
    v_cvt_pk_bf16_f32 v66, v30, v31
    s_add_u32 s44, s47, 163840
    buffer_store_short v66, v21, s[24:27], s44 offen
    buffer_store_short_d16_hi v66, v21, s[24:27], s44 offen offset:1280
    v_fmac_f32 v32, v78, v68
    v_fmac_f32 v33, v79, v69
    v_cvt_pk_bf16_f32 v68, v32, v33
    s_add_u32 s44, s47, 245760
    buffer_store_short v68, v21, s[24:27], s44 offen
    buffer_store_short_d16_hi v68, v21, s[24:27], s44 offen offset:1280
    v_fmac_f32 v34, v80, v70
    v_fmac_f32 v35, v81, v71
    v_cvt_pk_bf16_f32 v70, v34, v35
    buffer_store_short v70, v22, s[24:27], s51 offen
    buffer_store_short_d16_hi v70, v22, s[24:27], s51 offen offset:1280
L_done:
    s_endpgm
kernel_end:
.section .rodata,"a"
.p2align 6
.amdhsa_kernel recurrent_scan__spectral_gfnet__mixer_channel_mlp__prompt_kernel
  .amdhsa_next_free_vgpr 256
  .amdhsa_next_free_sgpr 102
  .amdhsa_accum_offset 256
  .amdhsa_group_segment_fixed_size 0
  .amdhsa_kernarg_size 88
  .amdhsa_user_sgpr_count 2
  .amdhsa_user_sgpr_kernarg_segment_ptr 1
  .amdhsa_system_sgpr_workgroup_id_x 1
  .amdhsa_float_denorm_mode_32 3
  .amdhsa_float_denorm_mode_16_64 3
.end_amdhsa_kernel
```
